```python
import torch

def _softmax(x, axis=-1):
    return torch.softmax(x, dim=axis)
def _gelu(x):
    return torch.nn.functional.gelu(x, approximate="tanh")
def _silu(x):
    return torch.nn.functional.silu(x)
def _sigmoid(x):
    return torch.sigmoid(x)
def _layernorm(x, axis=-1, eps=1e-5):
    m = x.mean(dim=axis, keepdim=True)
    v = x.var(dim=axis, keepdim=True, unbiased=False)
    return (x - m) / torch.sqrt(v + eps)
def _scatter_add(tgt, idx, src, axis=0):
    return tgt.clone().index_add_(axis, idx, src)
def _segment_sum(src, seg, n):
    out = torch.zeros((n,) + src.shape[1:], dtype=src.dtype)
    return out.index_add_(0, seg, src)
def _pad(x, pw):
    flat = tuple(v for pair in reversed(pw) for v in pair)
    return torch.nn.functional.pad(x, flat)

kernel_name = 'sequential_preLN__ssm_conv_h3__dense_activation_gelu__prompt'

def setup_inputs():

    _w = (lambda a: (lambda t: t.to(torch.bfloat16) if t.is_floating_point() else t)(torch.as_tensor(a)))
    def _A_setup():
        B, S, D = 1, 2048, 448
        ks = 4
        return {
            "q": _w((lambda *s: torch.randn(*s, dtype=torch.bfloat16) * 0.05)(B, S, D)),
            "k": _w((lambda *s: torch.randn(*s, dtype=torch.bfloat16) * 0.2)(B, S, D)),
            "v": _w((lambda *s: torch.randn(*s, dtype=torch.bfloat16) * 0.2)(B, S, D)),
            "shift_k": _w((lambda *s: torch.randn(*s, dtype=torch.bfloat16) * 0.2)(D, ks) * 0.5),
            "ssm_k": _w((lambda *s: torch.randn(*s, dtype=torch.bfloat16) * 0.4)(D, S) * (1.0 / S ** 0.5)),
            "ssm_D": _w((lambda *s: torch.randn(*s, dtype=torch.bfloat16) * 0.2)(D)),
        }
    _A_in = _A_setup()

    def _B_setup():
        B, S, D, F = 1, 2048, 448, 1792
        return {
            "x": _w((lambda *s: torch.randn(*s, dtype=torch.bfloat16) * 0.05)(B, S, D)),
            "w1": _w((lambda *s: torch.randn(*s, dtype=torch.bfloat16) * 0.4)(D, F) * (D ** -0.5)),
            "b1": _w((lambda *s: torch.randn(*s, dtype=torch.bfloat16) * 12.8)(F) * 0.01),
            "w2": _w((lambda *s: torch.randn(*s, dtype=torch.bfloat16) * 0.2)(F, D) * (F ** -0.5)),
            "b2": _w((lambda *s: torch.randn(*s, dtype=torch.bfloat16) * 1.6)(D) * 0.01),
        }
    _B_in = _B_setup()

    return {
        "A_q": _A_in["q"],
        "A_k": _A_in["k"],
        "A_v": _A_in["v"],
        "A_shift_k": _A_in["shift_k"],
        "A_ssm_k": _A_in["ssm_k"],
        "A_ssm_D": _A_in["ssm_D"],
        "B_x": _B_in["x"],
        "B_w1": _B_in["w1"],
        "B_b1": _B_in["b1"],
        "B_w2": _B_in["w2"],
        "B_b2": _B_in["b2"],
    }

def reference(A_q, A_k, A_v, A_shift_k, A_ssm_k, A_ssm_D, B_x, B_w1, B_b1, B_w2, B_b2):
    def _A_ref(q, k, v, shift_k, ssm_k, ssm_D):
        B, S, D = q.shape
        ks = shift_k.shape[-1]
        k_pad = _pad(k, ((0, 0), (ks - 1, 0), (0, 0)))
        k_shift = torch.zeros_like(k)
        for t in range(ks):
            k_shift = k_shift + k_pad[:, t:t + S, :] * shift_k[:, ks - 1 - t][None, None, :]
        kv = k_shift * v
        L = 2 * S
        kv_pad = _pad(kv, ((0, 0), (0, S), (0, 0)))
        kf_pad = _pad(ssm_k, ((0, 0), (0, S)))
        kv_f = (lambda x, axes=(-2,-1): torch.fft.rfft2(x.float(), dim=axes))(kv_pad[:, None, :, :], axes=(1, 2))
        kf_f = (lambda x, axes=(-2,-1): torch.fft.rfft2(x.float(), dim=axes))(kf_pad[:, None, :], axes=(1, 2))
        kf_f = (lambda x, *d: x.permute(*d))(kf_f, 1, 2, 0)
        y_f = kv_f * kf_f[None, :, :, :]
        y = (lambda x, s, axes=(-2,-1): torch.fft.irfft2(x, s=s, dim=axes).to(torch.bfloat16))(y_f, (1, L), axes=(1, 2))[:, 0, :S, :]
        y = y + kv * ssm_D[None, None, :]
        return q * y

    def _B_ref(x, w1, b1, w2, b2):
        h = torch.einsum("bsd,df->bsf", x, w1) + b1
        h = _gelu(h)
        return torch.einsum("bsf,fd->bsd", h, w2) + b2

    x = A_q
    h = x + _A_ref(_layernorm(x, axis=-1), A_k, A_v, A_shift_k, A_ssm_k, A_ssm_D)
    h2 = h + _B_ref(_layernorm(h, axis=-1), B_w1, B_b1, B_w2, B_b2)
    return h2
```

```asm
; @launch kernel=conv_kernel grid=(256,1,1) block=(320,1,1) lds=111616
; @launch kernel=ffn_kernel grid=(256,1,1) block=(256,1,1) lds=131072
.amdgcn_target "amdgcn-amd-amdhsa--gfx950"
.text
.globl conv_kernel
.p2align 8
.type conv_kernel,@function
conv_kernel:

s_load_dwordx8 s[4:11], s[0:1], 0
s_load_dwordx4 s[72:75], s[0:1], 32
s_load_dwordx4 s[76:79], s[0:1], 96
s_cmp_ge_u32 s2, 256
s_cbranch_scc1 conv_kernel_done
s_and_b32 s14, s2, 7
s_lshr_b32 s15, s2, 3
v_lshrrev_b32 v1, 6, v0
v_and_b32 v144, 63, v0
v_readfirstlane_b32 s66, v1
s_cmp_eq_u32 s14, 7
s_cbranch_scc1 conv_kernel_spare
s_cmp_eq_u32 s66, 4
s_cbranch_scc1 conv_kernel_helper
v_and_b32 v1, 31, v0
v_lshrrev_b32 v2, 5, v0
s_lshl_b32 s16, s15, 6
v_lshl_add_u32 v3, v2, 3, s16
s_movk_i32 s17, 896
v_mul_lo_u32 v4, v3, s17
s_lshl_b32 s18, s14, 7
v_lshl_add_u32 v5, v1, 2, s18
v_add_u32 v4, v4, v5
v_add_u32 v6, 4480, v4
v_subrev_u32 v7, 2688, v4
v_lshlrev_b32 v8, 2, v5
s_mov_b32 s26, 1835008
s_mov_b32 s27, 0x20000
s_mov_b32 s30, 1835008
s_mov_b32 s31, 0x20000
s_movk_i32 s34, 3584
s_mov_b32 s35, 0x20000
s_waitcnt lgkmcnt(0)
s_mov_b32 s24, s6
s_mov_b32 s25, s7
s_mov_b32 s28, s8
s_mov_b32 s29, s9
s_mov_b32 s32, s10
s_mov_b32 s33, s11

buffer_load_dword v16, v7, s[24:27], 0 offen offset:0
buffer_load_dword v17, v7, s[24:27], 0 offen offset:896
buffer_load_dword v18, v7, s[24:27], 0 offen offset:1792
buffer_load_dword v19, v4, s[24:27], 0 offen offset:0
buffer_load_dword v20, v4, s[24:27], 0 offen offset:896
buffer_load_dword v21, v4, s[24:27], 0 offen offset:1792
buffer_load_dword v22, v4, s[24:27], 0 offen offset:2688
buffer_load_dword v23, v4, s[24:27], 0 offen offset:3584
buffer_load_dword v24, v6, s[24:27], 0 offen offset:0
buffer_load_dword v25, v6, s[24:27], 0 offen offset:896
buffer_load_dword v26, v6, s[24:27], 0 offen offset:1792
buffer_load_dword v32, v4, s[28:31], 0 offen offset:0
buffer_load_dword v33, v4, s[28:31], 0 offen offset:896
buffer_load_dword v34, v4, s[28:31], 0 offen offset:1792
buffer_load_dword v35, v4, s[28:31], 0 offen offset:2688
buffer_load_dword v36, v4, s[28:31], 0 offen offset:3584
buffer_load_dword v37, v6, s[28:31], 0 offen offset:0
buffer_load_dword v38, v6, s[28:31], 0 offen offset:896
buffer_load_dword v39, v6, s[28:31], 0 offen offset:1792
buffer_load_dwordx4 v[48:51], v8, s[32:35], 0 offen

s_mov_b32 s12, s78
s_mov_b32 s13, s79
s_lshr_b32 s17, s66, 1
s_and_b32 s65, s66, 1
s_lshl_b32 s19, s14, 6
s_lshl_b32 s20, s15, 1
s_add_u32 s19, s19, s20
s_add_u32 s64, s19, s17
s_lshl_b32 s63, s64, 12
s_mul_i32 s62, s17, 39424
s_mov_b32 s20, s4
s_mov_b32 s21, s5
s_mov_b32 s22, 1835008
s_mov_b32 s23, 0x20000
s_add_u32 s40, s72, s63
s_addc_u32 s41, s73, 0
s_mov_b32 s42, 4096
s_mov_b32 s43, 0x20000
s_lshl_b32 s22, s65, 7
v_add_u32 v145, s22, v144
s_mov_b32 s22, 1835008
v_lshlrev_b32 v145, 4, v145
v_subrev_u32 v146, 16, v145
v_lshlrev_b32 v9, 11, v5
v_lshlrev_b32 v10, 1, v3
v_sub_u32 v11, v9, v10
v_add_u32 v11, 4080, v11
v_add_u32 v12, v9, v10
v_add_u32 v12, 2097152, v12
v_add_u32 v13, 4096, v11
v_add_u32 v14, 4096, v12
v_mov_b32 v62, 0xffff0000

s_add_u32 s36, s12, 0
s_addc_u32 s37, s13, 0
s_mov_b32 s38, 4194304
s_mov_b32 s39, 0x20000

s_waitcnt vmcnt(0)
v_lshlrev_b32 v52, 16, v48
v_lshlrev_b32 v53, 16, v50
v_and_b32 v54, v62, v48
v_and_b32 v55, v62, v50
v_lshlrev_b32 v56, 16, v49
v_lshlrev_b32 v57, 16, v51
v_and_b32 v58, v62, v49
v_and_b32 v59, v62, v51

v_lshlrev_b32 v64, 16, v16
v_and_b32 v65, v62, v16
v_lshlrev_b32 v66, 16, v17
v_and_b32 v67, v62, v17
v_lshlrev_b32 v68, 16, v18
v_and_b32 v69, v62, v18
v_lshlrev_b32 v70, 16, v19
v_and_b32 v71, v62, v19
v_lshlrev_b32 v72, 16, v20
v_and_b32 v73, v62, v20
v_lshlrev_b32 v74, 16, v21
v_and_b32 v75, v62, v21
v_lshlrev_b32 v76, 16, v22
v_and_b32 v77, v62, v22
v_lshlrev_b32 v78, 16, v23
v_and_b32 v79, v62, v23
v_lshlrev_b32 v80, 16, v24
v_and_b32 v81, v62, v24
v_lshlrev_b32 v82, 16, v25
v_and_b32 v83, v62, v25
v_lshlrev_b32 v84, 16, v26
v_and_b32 v85, v62, v26
v_pk_mul_f32 v[96:97], v[58:59], v[64:65]
v_pk_fma_f32 v[96:97], v[56:57], v[66:67], v[96:97]
v_pk_fma_f32 v[96:97], v[54:55], v[68:69], v[96:97]
v_pk_fma_f32 v[96:97], v[52:53], v[70:71], v[96:97]
v_pk_mul_f32 v[98:99], v[58:59], v[66:67]
v_pk_fma_f32 v[98:99], v[56:57], v[68:69], v[98:99]
v_pk_fma_f32 v[98:99], v[54:55], v[70:71], v[98:99]
v_pk_fma_f32 v[98:99], v[52:53], v[72:73], v[98:99]
v_pk_mul_f32 v[100:101], v[58:59], v[68:69]
v_pk_fma_f32 v[100:101], v[56:57], v[70:71], v[100:101]
v_pk_fma_f32 v[100:101], v[54:55], v[72:73], v[100:101]
v_pk_fma_f32 v[100:101], v[52:53], v[74:75], v[100:101]
v_pk_mul_f32 v[102:103], v[58:59], v[70:71]
v_pk_fma_f32 v[102:103], v[56:57], v[72:73], v[102:103]
v_pk_fma_f32 v[102:103], v[54:55], v[74:75], v[102:103]
v_pk_fma_f32 v[102:103], v[52:53], v[76:77], v[102:103]
v_pk_mul_f32 v[104:105], v[58:59], v[72:73]
v_pk_fma_f32 v[104:105], v[56:57], v[74:75], v[104:105]
v_pk_fma_f32 v[104:105], v[54:55], v[76:77], v[104:105]
v_pk_fma_f32 v[104:105], v[52:53], v[78:79], v[104:105]
v_pk_mul_f32 v[106:107], v[58:59], v[74:75]
v_pk_fma_f32 v[106:107], v[56:57], v[76:77], v[106:107]
v_pk_fma_f32 v[106:107], v[54:55], v[78:79], v[106:107]
v_pk_fma_f32 v[106:107], v[52:53], v[80:81], v[106:107]
v_pk_mul_f32 v[108:109], v[58:59], v[76:77]
v_pk_fma_f32 v[108:109], v[56:57], v[78:79], v[108:109]
v_pk_fma_f32 v[108:109], v[54:55], v[80:81], v[108:109]
v_pk_fma_f32 v[108:109], v[52:53], v[82:83], v[108:109]
v_pk_mul_f32 v[110:111], v[58:59], v[78:79]
v_pk_fma_f32 v[110:111], v[56:57], v[80:81], v[110:111]
v_pk_fma_f32 v[110:111], v[54:55], v[82:83], v[110:111]
v_pk_fma_f32 v[110:111], v[52:53], v[84:85], v[110:111]
v_lshlrev_b32 v60, 16, v32
v_and_b32 v61, v62, v32
v_pk_mul_f32 v[96:97], v[96:97], v[60:61]
v_lshlrev_b32 v60, 16, v33
v_and_b32 v61, v62, v33
v_pk_mul_f32 v[98:99], v[98:99], v[60:61]
v_lshlrev_b32 v60, 16, v34
v_and_b32 v61, v62, v34
v_pk_mul_f32 v[100:101], v[100:101], v[60:61]
v_lshlrev_b32 v60, 16, v35
v_and_b32 v61, v62, v35
v_pk_mul_f32 v[102:103], v[102:103], v[60:61]
v_lshlrev_b32 v60, 16, v36
v_and_b32 v61, v62, v36
v_pk_mul_f32 v[104:105], v[104:105], v[60:61]
v_lshlrev_b32 v60, 16, v37
v_and_b32 v61, v62, v37
v_pk_mul_f32 v[106:107], v[106:107], v[60:61]
v_lshlrev_b32 v60, 16, v38
v_and_b32 v61, v62, v38
v_pk_mul_f32 v[108:109], v[108:109], v[60:61]
v_lshlrev_b32 v60, 16, v39
v_and_b32 v61, v62, v39
v_pk_mul_f32 v[110:111], v[110:111], v[60:61]
v_cvt_pk_bf16_f32 v112, v110, v108
v_cvt_pk_bf16_f32 v116, v111, v109
v_cvt_pk_bf16_f32 v113, v106, v104
v_cvt_pk_bf16_f32 v117, v107, v105
v_cvt_pk_bf16_f32 v114, v102, v100
v_cvt_pk_bf16_f32 v118, v103, v101
v_cvt_pk_bf16_f32 v115, v98, v96
v_cvt_pk_bf16_f32 v119, v99, v97
buffer_store_dwordx4 v[112:115], v11, s[36:39], 0 offen
buffer_store_dwordx4 v[116:119], v13, s[36:39], 0 offen
buffer_load_dwordx4 v[128:131], v146, s[40:43], 0 offen
buffer_load_dwordx4 v[132:135], v145, s[40:43], 0 offen
buffer_load_dwordx4 v[136:139], v145, s[40:43], 0 offen offset:1008
buffer_load_dwordx4 v[140:143], v145, s[40:43], 0 offen offset:1024
buffer_load_dword v40, v4, s[20:23], 0 offen offset:0
buffer_load_dword v41, v4, s[20:23], 0 offen offset:896
buffer_load_dword v42, v4, s[20:23], 0 offen offset:1792
buffer_load_dword v43, v4, s[20:23], 0 offen offset:2688
buffer_load_dword v44, v4, s[20:23], 0 offen offset:3584
buffer_load_dword v45, v6, s[20:23], 0 offen offset:0
buffer_load_dword v46, v6, s[20:23], 0 offen offset:896
buffer_load_dword v47, v6, s[20:23], 0 offen offset:1792

v_and_b32 v161, 15, v144
v_lshrrev_b32 v162, 4, v144
v_add_u32 v160, s62, v145
v_add_u32 v160, 16, v160
v_add_u32 v163, 1, v161
v_and_b32 v164, 7, v163
v_lshrrev_b32 v165, 3, v163
v_add_u32 v165, v165, v162
v_lshlrev_b32 v165, 4, v165
s_mov_b32 s48, 0xc0b6e590
v_lshlrev_b32 v166, 2, v164
v_lshrrev_b32 v166, v166, s48
v_and_b32 v166, 15, v166
v_mul_u32_u24 v167, 272, v164
v_add_u32 v166, v166, v167
v_lshl_add_u32 v165, v166, 4, v165
v_add_u32 v165, s62, v165
v_mov_b32 v172, 0
v_mov_b32 v173, 0
v_mov_b32 v174, 0
v_mov_b32 v175, 0
s_mov_b64 exec, 0x7f
ds_write_b128 v165, v[172:175]
s_mov_b64 exec, 0x3fffffff
v_lshlrev_b32 v168, 4, v144
v_add_u32 v168, s62, v168
ds_write_b128 v168, v[172:175] offset:38912
s_mov_b64 exec, -1
s_lshl_b32 s16, s65, 8
v_add_u32 v165, s16, v165
v_lshlrev_b32 v169, 5, v161
v_lshlrev_b32 v170, 4, v162
v_sub_u32 v169, v170, v169
v_add_u32 v169, 35296, v169
v_add_u32 v169, s62, v169
v_add_u32 v169, s16, v169
s_waitcnt vmcnt(12)
s_barrier

s_mov_b32 s48, 0x05040100
s_mov_b32 s49, 0x07060302
s_waitcnt vmcnt(0)
v_perm_b32 v120, v41, v40, s48
v_perm_b32 v124, v41, v40, s49
v_perm_b32 v121, v43, v42, s48
v_perm_b32 v125, v43, v42, s49
v_perm_b32 v122, v45, v44, s48
v_perm_b32 v126, v45, v44, s49
v_perm_b32 v123, v47, v46, s48
v_perm_b32 v127, v47, v46, s49
buffer_store_dwordx4 v[120:123], v12, s[36:39], 0 offen
buffer_store_dwordx4 v[124:127], v14, s[36:39], 0 offen
ds_write_b128 v160, v[128:131] offset:0
ds_write_b128 v160, v[130:133] offset:17504
v_alignbit_b32 v96, v129, v128, 16
v_alignbit_b32 v97, v130, v129, 16
v_alignbit_b32 v98, v131, v130, 16
v_alignbit_b32 v99, v132, v131, 16
ds_write_b128 v160, v[96:99] offset:4496
v_alignbit_b32 v100, v130, v129, 16
v_alignbit_b32 v101, v131, v130, 16
v_alignbit_b32 v102, v132, v131, 16
v_alignbit_b32 v103, v133, v132, 16
ds_write_b128 v160, v[100:103] offset:13280
v_alignbit_b32 v104, v131, v130, 16
v_alignbit_b32 v105, v132, v131, 16
v_alignbit_b32 v106, v133, v132, 16
v_alignbit_b32 v107, v134, v133, 16
ds_write_b128 v160, v[104:107] offset:21936
v_alignbit_b32 v108, v132, v131, 16
v_alignbit_b32 v109, v133, v132, 16
v_alignbit_b32 v110, v134, v133, 16
v_alignbit_b32 v111, v135, v134, 16
ds_write_b128 v160, v[108:111] offset:30656
v_mov_b32 v88, v129
v_mov_b32 v89, v130
v_mov_b32 v90, v131
v_mov_b32 v91, v132
ds_write_b128 v160, v[88:91] offset:8784
v_mov_b32 v92, v131
v_mov_b32 v93, v132
v_mov_b32 v94, v133
v_mov_b32 v95, v134
ds_write_b128 v160, v[92:95] offset:26112
ds_write_b128 v160, v[136:139] offset:1024
ds_write_b128 v160, v[138:141] offset:18528
ds_write_b128 v160, v[140:143] offset:1040
v_alignbit_b32 v96, v137, v136, 16
v_alignbit_b32 v97, v138, v137, 16
v_alignbit_b32 v98, v139, v138, 16
v_alignbit_b32 v99, v140, v139, 16
ds_write_b128 v160, v[96:99] offset:5520
v_alignbit_b32 v100, v138, v137, 16
v_alignbit_b32 v101, v139, v138, 16
v_alignbit_b32 v102, v140, v139, 16
v_alignbit_b32 v103, v141, v140, 16
ds_write_b128 v160, v[100:103] offset:14304
v_alignbit_b32 v104, v139, v138, 16
v_alignbit_b32 v105, v140, v139, 16
v_alignbit_b32 v106, v141, v140, 16
v_alignbit_b32 v107, v142, v141, 16
ds_write_b128 v160, v[104:107] offset:22960
v_alignbit_b32 v108, v140, v139, 16
v_alignbit_b32 v109, v141, v140, 16
v_alignbit_b32 v110, v142, v141, 16
v_alignbit_b32 v111, v143, v142, 16
ds_write_b128 v160, v[108:111] offset:31680
v_mov_b32 v88, v137
v_mov_b32 v89, v138
v_mov_b32 v90, v139
v_mov_b32 v91, v140
ds_write_b128 v160, v[88:91] offset:9808
v_mov_b32 v92, v139
v_mov_b32 v93, v140
v_mov_b32 v94, v141
v_mov_b32 v95, v142
ds_write_b128 v160, v[92:95] offset:27136

v_mov_b32 v14, v165
v_mov_b32 v18, v169
s_add_u32 s28, s12, s63
s_addc_u32 s29, s13, 0
s_add_u32 s32, s28, 2097152
s_addc_u32 s33, s29, 0
s_mov_b32 s34, 4096
s_mov_b32 s35, 0x20000
s_add_u32 s36, s28, 5242880
s_addc_u32 s37, s29, 0
s_mov_b32 s38, 4096
s_mov_b32 s39, 0x20000
s_add_u32 s40, s12, 4194304
s_addc_u32 s41, s13, 0
s_mov_b32 s42, 16384
s_mov_b32 s43, 0x20000
s_mov_b32 s24, s74
s_mov_b32 s25, s75
s_movk_i32 s26, 896
s_mov_b32 s27, 0x20000
s_lshl_b32 s23, s64, 1
v_mov_b32 v6, s23
v_lshlrev_b32 v24, 4, v161
v_lshl_add_u32 v24, v162, 2, v24
s_lshl_b32 s22, s65, 10
v_add_u32 v24, s22, v24
v_lshlrev_b32 v25, 1, v24
v_lshlrev_b32 v26, 3, v24
v_add_u32 v27, 4096, v26
buffer_load_ushort v7, v6, s[24:27], 0 offen

s_mov_b32 s30, 4096
s_mov_b32 s31, 0x20000
s_lshl_b32 s22, s65, 11
s_add_u32 s22, s22, s62
s_add_u32 s22, s22, 34816
s_mov_b32 m0, s22
s_barrier
buffer_load_dwordx4 v145, s[28:31], 0 offen sc1 lds
buffer_load_dwordx4 v145, s[28:31], 0 offen offset:1024 sc1 lds

s_waitcnt vmcnt(0) lgkmcnt(0)
s_barrier

ds_read_b128 v[64:67], v14 offset:0
ds_read_b128 v[128:131], v18 offset:3584
ds_read_b128 v[68:71], v14 offset:512
ds_read_b128 v[132:135], v18 offset:3072
ds_read_b128 v[72:75], v14 offset:1024
ds_read_b128 v[136:139], v18 offset:2560
ds_read_b128 v[76:79], v14 offset:1536
ds_read_b128 v[140:143], v18 offset:2048
ds_read_b128 v[80:83], v14 offset:2048
ds_read_b128 v[144:147], v18 offset:1536
ds_read_b128 v[84:87], v14 offset:2560
ds_read_b128 v[148:151], v18 offset:1024
ds_read_b128 v[88:91], v14 offset:3072
ds_read_b128 v[152:155], v18 offset:512
ds_read_b128 v[92:95], v14 offset:3584
ds_read_b128 v[156:159], v18 offset:0
s_waitcnt lgkmcnt(14)
v_mfma_f32_16x16x32_bf16 v[32:35], v[64:67], v[128:131], 0
s_waitcnt lgkmcnt(12)
v_mfma_f32_16x16x32_bf16 v[36:39], v[64:67], v[132:135], 0
v_mfma_f32_16x16x32_bf16 v[36:39], v[68:71], v[128:131], v[36:39]
v_mfma_f32_16x16x32_bf16 v[40:43], v[68:71], v[132:135], 0
s_waitcnt lgkmcnt(10)
v_mfma_f32_16x16x32_bf16 v[40:43], v[64:67], v[136:139], v[40:43]
v_mfma_f32_16x16x32_bf16 v[44:47], v[68:71], v[136:139], 0
v_mfma_f32_16x16x32_bf16 v[40:43], v[72:75], v[128:131], v[40:43]
v_mfma_f32_16x16x32_bf16 v[44:47], v[72:75], v[132:135], v[44:47]
v_mfma_f32_16x16x32_bf16 v[48:51], v[72:75], v[136:139], 0
s_waitcnt lgkmcnt(8)
v_mfma_f32_16x16x32_bf16 v[44:47], v[64:67], v[140:143], v[44:47]
v_mfma_f32_16x16x32_bf16 v[48:51], v[68:71], v[140:143], v[48:51]
v_mfma_f32_16x16x32_bf16 v[52:55], v[72:75], v[140:143], 0
v_mfma_f32_16x16x32_bf16 v[44:47], v[76:79], v[128:131], v[44:47]
v_mfma_f32_16x16x32_bf16 v[48:51], v[76:79], v[132:135], v[48:51]
v_mfma_f32_16x16x32_bf16 v[52:55], v[76:79], v[136:139], v[52:55]
v_mfma_f32_16x16x32_bf16 v[56:59], v[76:79], v[140:143], 0
s_waitcnt lgkmcnt(6)
v_mfma_f32_16x16x32_bf16 v[48:51], v[64:67], v[144:147], v[48:51]
ds_read_b128 v[96:99], v14 offset:64
v_mfma_f32_16x16x32_bf16 v[52:55], v[68:71], v[144:147], v[52:55]
ds_read_b128 v[160:163], v18 offset:3648
v_mfma_f32_16x16x32_bf16 v[56:59], v[72:75], v[144:147], v[56:59]
ds_read_b128 v[100:103], v14 offset:576
v_mfma_f32_16x16x32_bf16 v[60:63], v[76:79], v[144:147], 0
ds_read_b128 v[164:167], v18 offset:3136
v_mfma_f32_16x16x32_bf16 v[48:51], v[80:83], v[128:131], v[48:51]
ds_read_b128 v[104:107], v14 offset:1088
v_mfma_f32_16x16x32_bf16 v[52:55], v[80:83], v[132:135], v[52:55]
ds_read_b128 v[168:171], v18 offset:2624
v_mfma_f32_16x16x32_bf16 v[56:59], v[80:83], v[136:139], v[56:59]
ds_read_b128 v[108:111], v14 offset:1600
v_mfma_f32_16x16x32_bf16 v[60:63], v[80:83], v[140:143], v[60:63]
ds_read_b128 v[172:175], v18 offset:2112
s_waitcnt lgkmcnt(12)
v_mfma_f32_16x16x32_bf16 v[52:55], v[64:67], v[148:151], v[52:55]
ds_read_b128 v[112:115], v14 offset:2112
v_mfma_f32_16x16x32_bf16 v[56:59], v[68:71], v[148:151], v[56:59]
ds_read_b128 v[176:179], v18 offset:1600
v_mfma_f32_16x16x32_bf16 v[60:63], v[72:75], v[148:151], v[60:63]
ds_read_b128 v[116:119], v14 offset:2624
v_mfma_f32_16x16x32_bf16 v[52:55], v[84:87], v[128:131], v[52:55]
ds_read_b128 v[180:183], v18 offset:1088
v_mfma_f32_16x16x32_bf16 v[56:59], v[84:87], v[132:135], v[56:59]
ds_read_b128 v[120:123], v14 offset:3136
v_mfma_f32_16x16x32_bf16 v[60:63], v[84:87], v[136:139], v[60:63]
ds_read_b128 v[184:187], v18 offset:576
s_waitcnt lgkmcnt(15)
v_mfma_f32_16x16x32_bf16 v[56:59], v[64:67], v[152:155], v[56:59]
ds_read_b128 v[124:127], v14 offset:3648
v_mfma_f32_16x16x32_bf16 v[60:63], v[68:71], v[152:155], v[60:63]
ds_read_b128 v[188:191], v18 offset:64
v_mfma_f32_16x16x32_bf16 v[56:59], v[88:91], v[128:131], v[56:59]
v_mfma_f32_16x16x32_bf16 v[60:63], v[88:91], v[132:135], v[60:63]
s_waitcnt lgkmcnt(15)
v_mfma_f32_16x16x32_bf16 v[60:63], v[64:67], v[156:159], v[60:63]
v_mfma_f32_16x16x32_bf16 v[60:63], v[92:95], v[128:131], v[60:63]
s_waitcnt lgkmcnt(0)
v_mfma_f32_16x16x32_bf16 v[32:35], v[96:99], v[160:163], v[32:35]
v_mfma_f32_16x16x32_bf16 v[36:39], v[96:99], v[164:167], v[36:39]
ds_read_b128 v[64:67], v14 offset:128
v_mfma_f32_16x16x32_bf16 v[36:39], v[100:103], v[160:163], v[36:39]
v_mfma_f32_16x16x32_bf16 v[40:43], v[100:103], v[164:167], v[40:43]
ds_read_b128 v[128:131], v18 offset:3712
v_mfma_f32_16x16x32_bf16 v[40:43], v[96:99], v[168:171], v[40:43]
v_mfma_f32_16x16x32_bf16 v[44:47], v[100:103], v[168:171], v[44:47]
ds_read_b128 v[68:71], v14 offset:640
v_mfma_f32_16x16x32_bf16 v[40:43], v[104:107], v[160:163], v[40:43]
v_mfma_f32_16x16x32_bf16 v[44:47], v[104:107], v[164:167], v[44:47]
ds_read_b128 v[132:135], v18 offset:3200
v_mfma_f32_16x16x32_bf16 v[48:51], v[104:107], v[168:171], v[48:51]
v_mfma_f32_16x16x32_bf16 v[44:47], v[96:99], v[172:175], v[44:47]
ds_read_b128 v[72:75], v14 offset:1152
v_mfma_f32_16x16x32_bf16 v[48:51], v[100:103], v[172:175], v[48:51]
v_mfma_f32_16x16x32_bf16 v[52:55], v[104:107], v[172:175], v[52:55]
ds_read_b128 v[136:139], v18 offset:2688
v_mfma_f32_16x16x32_bf16 v[44:47], v[108:111], v[160:163], v[44:47]
v_mfma_f32_16x16x32_bf16 v[48:51], v[108:111], v[164:167], v[48:51]
ds_read_b128 v[76:79], v14 offset:1664
v_mfma_f32_16x16x32_bf16 v[52:55], v[108:111], v[168:171], v[52:55]
v_mfma_f32_16x16x32_bf16 v[56:59], v[108:111], v[172:175], v[56:59]
ds_read_b128 v[140:143], v18 offset:2176
v_mfma_f32_16x16x32_bf16 v[48:51], v[96:99], v[176:179], v[48:51]
v_mfma_f32_16x16x32_bf16 v[52:55], v[100:103], v[176:179], v[52:55]
ds_read_b128 v[80:83], v14 offset:2176
v_mfma_f32_16x16x32_bf16 v[56:59], v[104:107], v[176:179], v[56:59]
v_mfma_f32_16x16x32_bf16 v[60:63], v[108:111], v[176:179], v[60:63]
ds_read_b128 v[144:147], v18 offset:1664
v_mfma_f32_16x16x32_bf16 v[48:51], v[112:115], v[160:163], v[48:51]
v_mfma_f32_16x16x32_bf16 v[52:55], v[112:115], v[164:167], v[52:55]
ds_read_b128 v[84:87], v14 offset:2688
v_mfma_f32_16x16x32_bf16 v[56:59], v[112:115], v[168:171], v[56:59]
v_mfma_f32_16x16x32_bf16 v[60:63], v[112:115], v[172:175], v[60:63]
ds_read_b128 v[148:151], v18 offset:1152
v_mfma_f32_16x16x32_bf16 v[52:55], v[96:99], v[180:183], v[52:55]
v_mfma_f32_16x16x32_bf16 v[56:59], v[100:103], v[180:183], v[56:59]
ds_read_b128 v[88:91], v14 offset:3200
v_mfma_f32_16x16x32_bf16 v[60:63], v[104:107], v[180:183], v[60:63]
v_mfma_f32_16x16x32_bf16 v[52:55], v[116:119], v[160:163], v[52:55]
ds_read_b128 v[152:155], v18 offset:640
v_mfma_f32_16x16x32_bf16 v[56:59], v[116:119], v[164:167], v[56:59]
v_mfma_f32_16x16x32_bf16 v[60:63], v[116:119], v[168:171], v[60:63]
ds_read_b128 v[92:95], v14 offset:3712
v_mfma_f32_16x16x32_bf16 v[56:59], v[96:99], v[184:187], v[56:59]
v_mfma_f32_16x16x32_bf16 v[60:63], v[100:103], v[184:187], v[60:63]
ds_read_b128 v[156:159], v18 offset:128
v_mfma_f32_16x16x32_bf16 v[56:59], v[120:123], v[160:163], v[56:59]
v_mfma_f32_16x16x32_bf16 v[60:63], v[120:123], v[164:167], v[60:63]
v_mfma_f32_16x16x32_bf16 v[60:63], v[96:99], v[188:191], v[60:63]
v_mfma_f32_16x16x32_bf16 v[60:63], v[124:127], v[160:163], v[60:63]
s_waitcnt lgkmcnt(0)
s_barrier
v_mfma_f32_16x16x32_bf16 v[32:35], v[64:67], v[128:131], v[32:35]
buffer_load_dwordx2 v[192:193], v25, s[32:35], 0 offen offset:0 sc1
v_mfma_f32_16x16x32_bf16 v[36:39], v[64:67], v[132:135], v[36:39]
ds_read_b128 v[96:99], v14 offset:192
v_mfma_f32_16x16x32_bf16 v[36:39], v[68:71], v[128:131], v[36:39]
buffer_load_dwordx4 v[200:203], v26, s[40:43], 0 offen offset:0 sc1
v_mfma_f32_16x16x32_bf16 v[40:43], v[68:71], v[132:135], v[40:43]
ds_read_b128 v[160:163], v18 offset:3776
v_mfma_f32_16x16x32_bf16 v[40:43], v[64:67], v[136:139], v[40:43]
buffer_load_dwordx4 v[204:207], v26, s[40:43], 0 offen offset:16 sc1
v_mfma_f32_16x16x32_bf16 v[44:47], v[68:71], v[136:139], v[44:47]
ds_read_b128 v[100:103], v14 offset:704
v_mfma_f32_16x16x32_bf16 v[40:43], v[72:75], v[128:131], v[40:43]
buffer_load_dwordx2 v[194:195], v25, s[32:35], 0 offen offset:512 sc1
v_mfma_f32_16x16x32_bf16 v[44:47], v[72:75], v[132:135], v[44:47]
ds_read_b128 v[164:167], v18 offset:3264
v_mfma_f32_16x16x32_bf16 v[48:51], v[72:75], v[136:139], v[48:51]
buffer_load_dwordx4 v[208:211], v26, s[40:43], 0 offen offset:2048 sc1
v_mfma_f32_16x16x32_bf16 v[44:47], v[64:67], v[140:143], v[44:47]
ds_read_b128 v[104:107], v14 offset:1216
v_mfma_f32_16x16x32_bf16 v[48:51], v[68:71], v[140:143], v[48:51]
buffer_load_dwordx4 v[212:215], v26, s[40:43], 0 offen offset:2064 sc1
v_mfma_f32_16x16x32_bf16 v[52:55], v[72:75], v[140:143], v[52:55]
ds_read_b128 v[168:171], v18 offset:2752
v_mfma_f32_16x16x32_bf16 v[44:47], v[76:79], v[128:131], v[44:47]
buffer_load_dwordx2 v[196:197], v25, s[32:35], 0 offen offset:1024 sc1
v_mfma_f32_16x16x32_bf16 v[48:51], v[76:79], v[132:135], v[48:51]
ds_read_b128 v[108:111], v14 offset:1728
v_mfma_f32_16x16x32_bf16 v[52:55], v[76:79], v[136:139], v[52:55]
buffer_load_dwordx4 v[216:219], v27, s[40:43], 0 offen offset:0 sc1
v_mfma_f32_16x16x32_bf16 v[56:59], v[76:79], v[140:143], v[56:59]
ds_read_b128 v[172:175], v18 offset:2240
v_mfma_f32_16x16x32_bf16 v[48:51], v[64:67], v[144:147], v[48:51]
buffer_load_dwordx4 v[220:223], v27, s[40:43], 0 offen offset:16 sc1
v_mfma_f32_16x16x32_bf16 v[52:55], v[68:71], v[144:147], v[52:55]
ds_read_b128 v[112:115], v14 offset:2240
v_mfma_f32_16x16x32_bf16 v[56:59], v[72:75], v[144:147], v[56:59]
buffer_load_dwordx2 v[198:199], v25, s[32:35], 0 offen offset:1536 sc1
v_mfma_f32_16x16x32_bf16 v[60:63], v[76:79], v[144:147], v[60:63]
ds_read_b128 v[176:179], v18 offset:1728
v_mfma_f32_16x16x32_bf16 v[48:51], v[80:83], v[128:131], v[48:51]
buffer_load_dwordx4 v[224:227], v27, s[40:43], 0 offen offset:2048 sc1
v_mfma_f32_16x16x32_bf16 v[52:55], v[80:83], v[132:135], v[52:55]
ds_read_b128 v[116:119], v14 offset:2752
v_mfma_f32_16x16x32_bf16 v[56:59], v[80:83], v[136:139], v[56:59]
buffer_load_dwordx4 v[228:231], v27, s[40:43], 0 offen offset:2064 sc1
v_mfma_f32_16x16x32_bf16 v[60:63], v[80:83], v[140:143], v[60:63]
ds_read_b128 v[180:183], v18 offset:1216
v_mfma_f32_16x16x32_bf16 v[52:55], v[64:67], v[148:151], v[52:55]
v_mfma_f32_16x16x32_bf16 v[56:59], v[68:71], v[148:151], v[56:59]
ds_read_b128 v[120:123], v14 offset:3264
v_mfma_f32_16x16x32_bf16 v[60:63], v[72:75], v[148:151], v[60:63]
v_mfma_f32_16x16x32_bf16 v[52:55], v[84:87], v[128:131], v[52:55]
ds_read_b128 v[184:187], v18 offset:704
v_mfma_f32_16x16x32_bf16 v[56:59], v[84:87], v[132:135], v[56:59]
v_mfma_f32_16x16x32_bf16 v[60:63], v[84:87], v[136:139], v[60:63]
ds_read_b128 v[124:127], v14 offset:3776
v_mfma_f32_16x16x32_bf16 v[56:59], v[64:67], v[152:155], v[56:59]
v_mfma_f32_16x16x32_bf16 v[60:63], v[68:71], v[152:155], v[60:63]
ds_read_b128 v[188:191], v18 offset:192
v_mfma_f32_16x16x32_bf16 v[56:59], v[88:91], v[128:131], v[56:59]
v_mfma_f32_16x16x32_bf16 v[60:63], v[88:91], v[132:135], v[60:63]
v_mfma_f32_16x16x32_bf16 v[60:63], v[64:67], v[156:159], v[60:63]
v_mfma_f32_16x16x32_bf16 v[60:63], v[92:95], v[128:131], v[60:63]
s_waitcnt lgkmcnt(0)
v_mfma_f32_16x16x32_bf16 v[32:35], v[96:99], v[160:163], v[32:35]
v_mfma_f32_16x16x32_bf16 v[36:39], v[96:99], v[164:167], v[36:39]
v_mfma_f32_16x16x32_bf16 v[36:39], v[100:103], v[160:163], v[36:39]
v_mfma_f32_16x16x32_bf16 v[40:43], v[100:103], v[164:167], v[40:43]
v_mfma_f32_16x16x32_bf16 v[40:43], v[96:99], v[168:171], v[40:43]
v_mfma_f32_16x16x32_bf16 v[44:47], v[100:103], v[168:171], v[44:47]
v_mfma_f32_16x16x32_bf16 v[40:43], v[104:107], v[160:163], v[40:43]
v_mfma_f32_16x16x32_bf16 v[44:47], v[104:107], v[164:167], v[44:47]
v_mfma_f32_16x16x32_bf16 v[48:51], v[104:107], v[168:171], v[48:51]
v_mfma_f32_16x16x32_bf16 v[44:47], v[96:99], v[172:175], v[44:47]
v_mfma_f32_16x16x32_bf16 v[48:51], v[100:103], v[172:175], v[48:51]
v_mfma_f32_16x16x32_bf16 v[52:55], v[104:107], v[172:175], v[52:55]
v_mfma_f32_16x16x32_bf16 v[44:47], v[108:111], v[160:163], v[44:47]
v_mfma_f32_16x16x32_bf16 v[48:51], v[108:111], v[164:167], v[48:51]
v_mfma_f32_16x16x32_bf16 v[52:55], v[108:111], v[168:171], v[52:55]
v_mfma_f32_16x16x32_bf16 v[56:59], v[108:111], v[172:175], v[56:59]
v_mfma_f32_16x16x32_bf16 v[48:51], v[96:99], v[176:179], v[48:51]
v_mfma_f32_16x16x32_bf16 v[52:55], v[100:103], v[176:179], v[52:55]
v_mfma_f32_16x16x32_bf16 v[56:59], v[104:107], v[176:179], v[56:59]
v_mfma_f32_16x16x32_bf16 v[60:63], v[108:111], v[176:179], v[60:63]
v_mfma_f32_16x16x32_bf16 v[48:51], v[112:115], v[160:163], v[48:51]
v_mfma_f32_16x16x32_bf16 v[52:55], v[112:115], v[164:167], v[52:55]
v_mfma_f32_16x16x32_bf16 v[56:59], v[112:115], v[168:171], v[56:59]
v_mfma_f32_16x16x32_bf16 v[60:63], v[112:115], v[172:175], v[60:63]
v_mfma_f32_16x16x32_bf16 v[52:55], v[96:99], v[180:183], v[52:55]
v_mfma_f32_16x16x32_bf16 v[56:59], v[100:103], v[180:183], v[56:59]
v_mfma_f32_16x16x32_bf16 v[60:63], v[104:107], v[180:183], v[60:63]
v_mfma_f32_16x16x32_bf16 v[52:55], v[116:119], v[160:163], v[52:55]
v_mfma_f32_16x16x32_bf16 v[56:59], v[116:119], v[164:167], v[56:59]
v_mfma_f32_16x16x32_bf16 v[60:63], v[116:119], v[168:171], v[60:63]
v_mfma_f32_16x16x32_bf16 v[56:59], v[96:99], v[184:187], v[56:59]
v_mfma_f32_16x16x32_bf16 v[60:63], v[100:103], v[184:187], v[60:63]
v_mfma_f32_16x16x32_bf16 v[56:59], v[120:123], v[160:163], v[56:59]
v_mfma_f32_16x16x32_bf16 v[60:63], v[120:123], v[164:167], v[60:63]
v_mfma_f32_16x16x32_bf16 v[60:63], v[96:99], v[188:191], v[60:63]
v_mfma_f32_16x16x32_bf16 v[60:63], v[124:127], v[160:163], v[60:63]

v_lshlrev_b32 v28, 4, v144
v_and_b32 v28, 63, v0
v_lshlrev_b32 v28, 4, v28
s_lshl_b32 s22, s66, 12
s_add_u32 s22, s22, 78848
v_add_u32 v29, s22, v28
s_xor_b32 s23, s66, 1
s_lshl_b32 s23, s23, 12
s_add_u32 s23, s23, 78848
v_add_u32 v30, s23, v28
v_lshlrev_b32 v31, 1, v24
v_sub_u32 v31, 37368, v31
v_add_u32 v31, s62, v31
s_cmp_eq_u32 s65, 0
s_cbranch_scc0 conv_kernel_hb1

ds_write_b128 v29, v[48:51] offset:0
ds_write_b128 v29, v[52:55] offset:1024
ds_write_b128 v29, v[56:59] offset:2048
ds_write_b128 v29, v[60:63] offset:3072
s_branch conv_kernel_x
conv_kernel_hb1:
ds_write_b128 v29, v[32:35] offset:0
ds_write_b128 v29, v[36:39] offset:1024
ds_write_b128 v29, v[40:43] offset:2048
ds_write_b128 v29, v[44:47] offset:3072
v_mov_b32 v32, v48
v_mov_b32 v33, v49
v_mov_b32 v34, v50
v_mov_b32 v35, v51
v_mov_b32 v36, v52
v_mov_b32 v37, v53
v_mov_b32 v38, v54
v_mov_b32 v39, v55
v_mov_b32 v40, v56
v_mov_b32 v41, v57
v_mov_b32 v42, v58
v_mov_b32 v43, v59
v_mov_b32 v44, v60
v_mov_b32 v45, v61
v_mov_b32 v46, v62
v_mov_b32 v47, v63
conv_kernel_x:
ds_read_b64 v[80:81], v31 offset:1536
ds_read_b64 v[82:83], v31 offset:1024
ds_read_b64 v[84:85], v31 offset:512
ds_read_b64 v[86:87], v31 offset:0
s_waitcnt lgkmcnt(0)
s_barrier
ds_read_b128 v[64:67], v30 offset:0
ds_read_b128 v[68:71], v30 offset:1024
ds_read_b128 v[72:75], v30 offset:2048
ds_read_b128 v[76:79], v30 offset:3072
s_waitcnt vmcnt(0)
v_lshlrev_b32 v7, 16, v7
v_mov_b32 v6, 0xffff0000
v_and_b32 v88, v6, v81
v_lshlrev_b32 v89, 16, v81
v_and_b32 v90, v6, v80
v_lshlrev_b32 v91, 16, v80
v_lshlrev_b32 v96, 16, v192
v_and_b32 v97, v6, v192
v_lshlrev_b32 v98, 16, v193
v_and_b32 v99, v6, v193
v_fma_f32 v112, v96, v200, v201
v_fmac_f32 v32, v88, v7
v_fma_f32 v113, v97, v202, v203
v_fmac_f32 v33, v89, v7
v_fma_f32 v114, v98, v204, v205
v_fmac_f32 v34, v90, v7
v_fma_f32 v115, v99, v206, v207
v_fmac_f32 v35, v91, v7
s_waitcnt lgkmcnt(0)
v_add_f32 v32, v32, v64
v_add_f32 v33, v33, v65
v_add_f32 v34, v34, v66
v_add_f32 v35, v35, v67
v_fmac_f32 v96, v112, v32
v_fmac_f32 v97, v113, v33
v_fmac_f32 v98, v114, v34
v_fmac_f32 v99, v115, v35
v_cvt_pk_bf16_f32 v128, v96, v97
v_cvt_pk_bf16_f32 v129, v98, v99
buffer_store_dwordx2 v[128:129], v25, s[36:39], 0 offen offset:0
v_and_b32 v88, v6, v83
v_lshlrev_b32 v89, 16, v83
v_and_b32 v90, v6, v82
v_lshlrev_b32 v91, 16, v82
v_lshlrev_b32 v100, 16, v194
v_and_b32 v101, v6, v194
v_lshlrev_b32 v102, 16, v195
v_and_b32 v103, v6, v195
v_fma_f32 v116, v100, v208, v209
v_fmac_f32 v36, v88, v7
v_fma_f32 v117, v101, v210, v211
v_fmac_f32 v37, v89, v7
v_fma_f32 v118, v102, v212, v213
v_fmac_f32 v38, v90, v7
v_fma_f32 v119, v103, v214, v215
v_fmac_f32 v39, v91, v7
v_add_f32 v36, v36, v68
v_add_f32 v37, v37, v69
v_add_f32 v38, v38, v70
v_add_f32 v39, v39, v71
v_fmac_f32 v100, v116, v36
v_fmac_f32 v101, v117, v37
v_fmac_f32 v102, v118, v38
v_fmac_f32 v103, v119, v39
v_cvt_pk_bf16_f32 v130, v100, v101
v_cvt_pk_bf16_f32 v131, v102, v103
buffer_store_dwordx2 v[130:131], v25, s[36:39], 0 offen offset:512
v_and_b32 v88, v6, v85
v_lshlrev_b32 v89, 16, v85
v_and_b32 v90, v6, v84
v_lshlrev_b32 v91, 16, v84
v_lshlrev_b32 v104, 16, v196
v_and_b32 v105, v6, v196
v_lshlrev_b32 v106, 16, v197
v_and_b32 v107, v6, v197
v_fma_f32 v120, v104, v216, v217
v_fmac_f32 v40, v88, v7
v_fma_f32 v121, v105, v218, v219
v_fmac_f32 v41, v89, v7
v_fma_f32 v122, v106, v220, v221
v_fmac_f32 v42, v90, v7
v_fma_f32 v123, v107, v222, v223
v_fmac_f32 v43, v91, v7
v_add_f32 v40, v40, v72
v_add_f32 v41, v41, v73
v_add_f32 v42, v42, v74
v_add_f32 v43, v43, v75
v_fmac_f32 v104, v120, v40
v_fmac_f32 v105, v121, v41
v_fmac_f32 v106, v122, v42
v_fmac_f32 v107, v123, v43
v_cvt_pk_bf16_f32 v132, v104, v105
v_cvt_pk_bf16_f32 v133, v106, v107
buffer_store_dwordx2 v[132:133], v25, s[36:39], 0 offen offset:1024
v_and_b32 v88, v6, v87
v_lshlrev_b32 v89, 16, v87
v_and_b32 v90, v6, v86
v_lshlrev_b32 v91, 16, v86
v_lshlrev_b32 v108, 16, v198
v_and_b32 v109, v6, v198
v_lshlrev_b32 v110, 16, v199
v_and_b32 v111, v6, v199
v_fma_f32 v124, v108, v224, v225
v_fmac_f32 v44, v88, v7
v_fma_f32 v125, v109, v226, v227
v_fmac_f32 v45, v89, v7
v_fma_f32 v126, v110, v228, v229
v_fmac_f32 v46, v90, v7
v_fma_f32 v127, v111, v230, v231
v_fmac_f32 v47, v91, v7
v_add_f32 v44, v44, v76
v_add_f32 v45, v45, v77
v_add_f32 v46, v46, v78
v_add_f32 v47, v47, v79
v_fmac_f32 v108, v124, v44
v_fmac_f32 v109, v125, v45
v_fmac_f32 v110, v126, v46
v_fmac_f32 v111, v127, v47
v_cvt_pk_bf16_f32 v134, v108, v109
v_cvt_pk_bf16_f32 v135, v110, v111
buffer_store_dwordx2 v[134:135], v25, s[36:39], 0 offen offset:1536
s_endpgm
conv_kernel_helper:
s_load_dwordx2 s[70:71], s[0:1], 56
s_load_dwordx2 s[50:51], s[0:1], 72
s_memrealtime s[68:69]
s_getreg_b32 s67, hwreg(HW_REG_XCC_ID)
s_and_b32 s67, s67, 7
s_lshl_b32 s18, s14, 5
s_add_u32 s18, s18, s15
s_min_u32 s18, s18, 195
s_lshl_b32 s18, s18, 2
s_mul_i32 s19, s18, 4682
s_lshr_b32 s19, s19, 19
s_mul_i32 s21, s19, 112
s_sub_u32 s21, s18, s21
s_mul_i32 s3, s21, 14336
s_lshl_b32 s23, s19, 7
s_add_u32 s3, s3, s23
s_lshl_b32 s18, s18, 11
v_lshrrev_b32 v147, 3, v144
v_and_b32 v148, 7, v144
v_bfe_u32 v149, v144, 4, 1
v_lshlrev_b32 v149, 2, v149
v_xor_b32 v148, v148, v149
v_lshlrev_b32 v148, 4, v148
s_movk_i32 s21, 896
v_mul_lo_u32 v147, v147, s21
v_add_u32 v147, v147, v148
s_waitcnt lgkmcnt(0)
s_mov_b32 s12, s78
s_mov_b32 s13, s79
s_mov_b32 s56, s76
s_mov_b32 s57, s77
s_mov_b32 s58, 256
s_mov_b32 s59, 0x20000
s_cmp_lg_u32 s2, 0
s_cbranch_scc1 conv_kernel_non
s_and_b32 s68, s68, 0xfffffff0
s_or_b32 s68, s68, 0x10
v_mov_b32 v30, s68
v_mov_b32 v31, 0
s_mov_b64 exec, 1
buffer_store_dword v30, v31, s[56:59], 0 offen sc1
s_mov_b64 exec, -1
conv_kernel_non:

s_add_u32 s44, s12, 4587520
s_addc_u32 s45, s13, 0
s_mov_b32 s46, 32768
s_mov_b32 s47, 0x20000

s_lshl_b32 s19, s14, 6
s_lshl_b32 s21, s15, 1
s_add_u32 s19, s19, s21
s_lshl_b32 s63, s19, 12
s_add_u32 s28, s12, s63
s_addc_u32 s29, s13, 0
s_mov_b32 s30, 8192
s_mov_b32 s31, 0x20000
v_lshlrev_b32 v2, 2, v144
s_lshl_b32 s21, s14, 7
buffer_load_dword v40, v2, s[44:47], s21 offen
buffer_load_dword v40, v2, s[44:47], s21 offen offset:1024
v_lshlrev_b32 v2, 7, v144
buffer_load_dword v41, v2, s[28:31], 0 offen
s_add_u32 s28, s28, 2097152
s_addc_u32 s29, s29, 0

buffer_load_dword v41, v2, s[28:31], 0 offen
v_mov_b32 v31, 0
s_mov_b32 s60, 0
conv_kernel_nph:
buffer_load_dword v29, v31, s[56:59], 0 offen sc1
s_waitcnt vmcnt(0)
v_readfirstlane_b32 s61, v29
s_cmp_lg_u32 s61, 0
s_cbranch_scc1 conv_kernel_npxh
s_add_u32 s60, s60, 1
s_cmp_gt_u32 s60, 0x100000
s_cbranch_scc1 conv_kernel_npxh
s_sleep 2
s_branch conv_kernel_nph
conv_kernel_npxh:

s_add_u32 s60, s61, s67
s_mov_b32 s20, s50
s_mov_b32 s21, s51
s_mov_b32 s22, 1605632
s_mov_b32 s23, 0x20000
s_mov_b32 m0, 95232
buffer_load_dwordx4 v147, s[20:23], s3 offen lds
s_add_u32 s3, s3, 7168
s_add_u32 m0, m0, 1024
buffer_load_dwordx4 v147, s[20:23], s3 offen lds
s_add_u32 s3, s3, 7168
s_add_u32 m0, m0, 1024
buffer_load_dwordx4 v147, s[20:23], s3 offen lds
s_add_u32 s3, s3, 7168
s_add_u32 m0, m0, 1024
buffer_load_dwordx4 v147, s[20:23], s3 offen lds
s_add_u32 s3, s3, 7168
s_add_u32 m0, m0, 1024
buffer_load_dwordx4 v147, s[20:23], s3 offen lds
s_add_u32 s3, s3, 7168
s_add_u32 m0, m0, 1024
buffer_load_dwordx4 v147, s[20:23], s3 offen lds
s_add_u32 s3, s3, 7168
s_add_u32 m0, m0, 1024
buffer_load_dwordx4 v147, s[20:23], s3 offen lds
s_add_u32 s3, s3, 7168
s_add_u32 m0, m0, 1024
buffer_load_dwordx4 v147, s[20:23], s3 offen lds
s_add_u32 s3, s3, 7168
s_add_u32 m0, m0, 1024

s_lshl_b32 s19, s14, 6
s_lshl_b32 s21, s15, 1
s_add_u32 s19, s19, s21
s_lshl_b32 s63, s19, 12
s_add_u32 s28, s12, s63
s_addc_u32 s29, s13, 0
s_mov_b32 s30, 4096
s_mov_b32 s31, 0x20000
s_add_u32 s32, s28, 4096
s_addc_u32 s33, s29, 0
s_mov_b32 s34, 4096
s_mov_b32 s35, 0x20000

v_lshlrev_b32 v2, 2, v144
s_lshl_b32 s50, s14, 7
s_add_u32 s50, s50, 0
v_add_u32 v2, s50, v2
v_subrev_u32 v3, 32, v144
v_lshlrev_b32 v3, 6, v3
s_lshl_b32 s51, s14, 11
s_add_u32 s51, s51, 2048
v_add_u32 v3, s51, v3
v_cmp_gt_u32 vcc, 32, v144
s_add_u32 s49, s61, 15
v_mov_b32 v4, s49
v_mov_b32 v5, s60
v_cndmask_b32 v2, v3, v2, vcc
v_cndmask_b32 v4, v4, v5, vcc

v_lshlrev_b32 v10, 2, v144
s_lshl_b32 s50, s14, 7
s_add_u32 s50, s50, 1024
v_add_u32 v10, s50, v10
v_subrev_u32 v3, 32, v144
v_lshlrev_b32 v3, 6, v3
s_lshl_b32 s53, s14, 11
s_add_u32 s53, s53, 16384
v_add_u32 v3, s53, v3
v_cmp_gt_u32 vcc, 32, v144
s_add_u32 s49, s61, 15
v_mov_b32 v4, s49
v_mov_b32 v5, s60
v_cndmask_b32 v10, v3, v10, vcc
v_cndmask_b32 v4, v4, v5, vcc

v_mov_b32 v28, s60
s_lshl_b32 s36, s14, 7
s_lshl_b32 s37, s15, 2
s_add_u32 s36, s36, s37
s_barrier
s_mov_b64 exec, 1
buffer_store_dword v28, v31, s[44:47], s36 offen offset:0
s_mov_b64 exec, -1

s_mov_b32 s48, 0
conv_kernel_pla:
buffer_load_dword v7, v2, s[44:47], 0 offen sc1
s_waitcnt vmcnt(0)
v_cmp_eq_u32 vcc, v4, v7
s_or_b32 s50, vcc_lo, vcc_hi
s_cmp_eq_u32 s50, -1
s_cbranch_scc1 conv_kernel_plxa
s_add_u32 s48, s48, 1
s_cmp_eq_u32 s48, 24
s_cbranch_scc0 conv_kernel_plca
buffer_wbl2 sc1
s_waitcnt vmcnt(0)
s_lshl_b32 s50, s15, 6
s_add_u32 s50, s50, s51
v_mov_b32 v5, s49
s_mov_b64 exec, 1
buffer_store_dword v5, v31, s[44:47], s50 offen sc1
s_mov_b64 exec, -1
conv_kernel_plca:
s_cmp_gt_u32 s48, 0x100000
s_cbranch_scc1 conv_kernel_plxa
s_sleep 1
s_branch conv_kernel_pla
conv_kernel_plxa:
s_cmp_eq_u32 vcc_lo, -1
s_cbranch_scc1 conv_kernel_plya
s_cmp_ge_u32 s48, 24
s_cbranch_scc1 conv_kernel_plya
buffer_wbl2 sc1
s_waitcnt vmcnt(0)
s_lshl_b32 s50, s15, 6
s_add_u32 s50, s50, s51
v_mov_b32 v5, s49
s_mov_b64 exec, 1
buffer_store_dword v5, v31, s[44:47], s50 offen sc1
s_mov_b64 exec, -1
conv_kernel_plya:

s_barrier
s_barrier
s_mov_b64 exec, 1
buffer_store_dword v28, v31, s[44:47], s36 offen offset:1024
s_mov_b64 exec, -1

s_mov_b32 s48, 0
conv_kernel_plx:
buffer_load_dword v7, v10, s[44:47], 0 offen sc1
s_waitcnt vmcnt(0)
v_cmp_eq_u32 vcc, v4, v7
s_or_b32 s50, vcc_lo, vcc_hi
s_cmp_eq_u32 s50, -1
s_cbranch_scc1 conv_kernel_plxx
s_add_u32 s48, s48, 1
s_cmp_eq_u32 s48, 24
s_cbranch_scc0 conv_kernel_plcx
buffer_wbl2 sc1
s_waitcnt vmcnt(0)
s_lshl_b32 s50, s15, 6
s_add_u32 s50, s50, s53
v_mov_b32 v5, s49
s_mov_b64 exec, 1
buffer_store_dword v5, v31, s[44:47], s50 offen sc1
s_mov_b64 exec, -1
conv_kernel_plcx:
s_cmp_gt_u32 s48, 0x100000
s_cbranch_scc1 conv_kernel_plxx
s_sleep 1
s_branch conv_kernel_plx
conv_kernel_plxx:
s_cmp_eq_u32 vcc_lo, -1
s_cbranch_scc1 conv_kernel_plyx
s_cmp_ge_u32 s48, 24
s_cbranch_scc1 conv_kernel_plyx
buffer_wbl2 sc1
s_waitcnt vmcnt(0)
s_lshl_b32 s50, s15, 6
s_add_u32 s50, s50, s53
v_mov_b32 v5, s49
s_mov_b64 exec, 1
buffer_store_dword v5, v31, s[44:47], s50 offen sc1
s_mov_b64 exec, -1
conv_kernel_plyx:

v_lshlrev_b32 v9, 6, v144
v_add_u32 v9, 30720, v9
s_mov_b64 exec, 0xffffffff
s_mov_b32 s48, 0
conv_kernel_spl:
buffer_load_dword v5, v9, s[44:47], 0 offen sc1
s_waitcnt vmcnt(0)
v_cmp_ne_u32 vcc, s61, v5
s_cbranch_vccz conv_kernel_sok
s_add_u32 s48, s48, 1
s_cmp_gt_u32 s48, 0x100000
s_cbranch_scc1 conv_kernel_sok
s_sleep 1
s_branch conv_kernel_spl
conv_kernel_sok:
s_mov_b64 exec, -1
s_barrier

v_bfe_u32 v7, v144, 2, 2
v_lshrrev_b32 v6, 5, v144
v_lshl_add_u32 v6, v6, 2, v7
v_lshlrev_b32 v4, 7, v6
v_lshrrev_b32 v7, 1, v7
v_lshl_add_u32 v4, v7, 6, v4
v_bfe_u32 v7, v144, 4, 1
v_lshl_add_u32 v4, v7, 5, v4
v_and_b32 v7, 3, v144
v_lshl_add_u32 v4, v7, 3, v4
v_add_u32 v4, 95232, v4
v_xor_b32 v5, 64, v4

ds_read_b64_tr_b16 v[64:65], v4 offset:0
ds_read_b64_tr_b16 v[66:67], v4 offset:1024
ds_read_b64_tr_b16 v[68:69], v5 offset:0
ds_read_b64_tr_b16 v[70:71], v5 offset:1024
ds_read_b64_tr_b16 v[72:73], v4 offset:2048
ds_read_b64_tr_b16 v[74:75], v4 offset:3072
ds_read_b64_tr_b16 v[76:77], v5 offset:2048
ds_read_b64_tr_b16 v[78:79], v5 offset:3072
ds_read_b64_tr_b16 v[80:81], v4 offset:4096
ds_read_b64_tr_b16 v[82:83], v4 offset:5120
ds_read_b64_tr_b16 v[84:85], v5 offset:4096
ds_read_b64_tr_b16 v[86:87], v5 offset:5120
ds_read_b64_tr_b16 v[88:89], v4 offset:6144
ds_read_b64_tr_b16 v[90:91], v4 offset:7168
ds_read_b64_tr_b16 v[92:93], v5 offset:6144
ds_read_b64_tr_b16 v[94:95], v5 offset:7168
s_add_u32 s20, s12, 18382848
s_addc_u32 s21, s13, 0
s_mov_b32 s22, 1605632
s_mov_b32 s23, 0x20000
v_lshlrev_b32 v8, 4, v144
v_add_u32 v9, 4096, v8
s_waitcnt lgkmcnt(0)
buffer_store_dwordx4 v[64:67], v8, s[20:23], s18 offen offset:0 sc1
buffer_store_dwordx4 v[68:71], v8, s[20:23], s18 offen offset:1024 sc1
buffer_store_dwordx4 v[72:75], v8, s[20:23], s18 offen offset:2048 sc1
buffer_store_dwordx4 v[76:79], v8, s[20:23], s18 offen offset:3072 sc1
buffer_store_dwordx4 v[80:83], v9, s[20:23], s18 offen offset:0 sc1
buffer_store_dwordx4 v[84:87], v9, s[20:23], s18 offen offset:1024 sc1
buffer_store_dwordx4 v[88:91], v9, s[20:23], s18 offen offset:2048 sc1
buffer_store_dwordx4 v[92:95], v9, s[20:23], s18 offen offset:3072 sc1
s_add_u32 s52, s12, 4325376
s_addc_u32 s53, s13, 0
s_mov_b32 s54, 229376
s_mov_b32 s55, 0x20000

s_lshl_b32 s60, s14, 5
s_add_u32 s60, s60, s15
s_lshl_b32 s60, s60, 10
v_lshlrev_b32 v30, 4, v144
v_mov_b32 v32, 0
v_mov_b32 v33, 0
v_mov_b32 v34, 0
v_mov_b32 v35, 0
buffer_store_dwordx4 v[32:35], v30, s[52:55], s60 offen
s_add_u32 s52, s12, 8388608
s_addc_u32 s53, s13, 0
s_mov_b32 s54, 7340032
s_mov_b32 s55, 0x20000
s_mul_i32 s56, s14, 917504
s_mul_i32 s57, s15, 28672
s_add_u32 s56, s56, s57

v_lshlrev_b32 v31, 7, v144
s_barrier
s_endpgm
conv_kernel_spare:
s_load_dwordx2 s[70:71], s[0:1], 56
s_cmp_eq_u32 s66, 4
s_cbranch_scc1 conv_kernel_sph
v_lshrrev_b32 v57, 2, v0
v_and_b32 v58, 3, v0
s_lshl_b32 s16, s15, 6
v_add_u32 v59, s16, v57
s_movk_i32 s17, 896
v_mul_lo_u32 v60, v59, s17
v_lshl_add_u32 v60, v58, 4, v60
s_min_u32 s19, s15, 27
v_and_b32 v61, 7, v0
v_lshrrev_b32 v62, 3, v0
s_mov_b32 s17, 50176
v_mul_lo_u32 v62, v62, s17
v_lshl_add_u32 v62, v61, 4, v62
s_lshl_b32 s21, s19, 7
s_waitcnt lgkmcnt(0)
s_mov_b32 s12, s78
s_mov_b32 s13, s79

s_mov_b32 s32, s4
s_mov_b32 s33, s5
s_mov_b32 s34, 1835008
s_mov_b32 s35, 0x20000
buffer_load_dwordx4 v[64:67], v60, s[32:35], 0 offen offset:0
buffer_load_dwordx4 v[68:71], v60, s[32:35], 0 offen offset:64
buffer_load_dwordx4 v[72:75], v60, s[32:35], 0 offen offset:128
buffer_load_dwordx4 v[76:79], v60, s[32:35], 0 offen offset:192
buffer_load_dwordx4 v[80:83], v60, s[32:35], 0 offen offset:256
buffer_load_dwordx4 v[84:87], v60, s[32:35], 0 offen offset:320
buffer_load_dwordx4 v[88:91], v60, s[32:35], 0 offen offset:384
buffer_load_dwordx4 v[92:95], v60, s[32:35], 0 offen offset:448
buffer_load_dwordx4 v[96:99], v60, s[32:35], 0 offen offset:512
buffer_load_dwordx4 v[100:103], v60, s[32:35], 0 offen offset:576
buffer_load_dwordx4 v[104:107], v60, s[32:35], 0 offen offset:640
buffer_load_dwordx4 v[108:111], v60, s[32:35], 0 offen offset:704
buffer_load_dwordx4 v[112:115], v60, s[32:35], 0 offen offset:768
buffer_load_dwordx4 v[116:119], v60, s[32:35], 0 offen offset:832
s_add_u32 s36, s12, 4194304
s_addc_u32 s37, s13, 0
s_mov_b32 s38, 16384
s_mov_b32 s39, 0x20000
s_mov_b32 s40, 0x3f803f80
v_mov_b32 v8, 0
v_mov_b32 v9, 0
v_mov_b32 v12, 0
v_mov_b32 v13, 0
s_waitcnt vmcnt(10)
v_dot2_f32_bf16 v8, v64, s40, v8
v_dot2_f32_bf16 v12, v64, v64, v12
v_dot2_f32_bf16 v9, v65, s40, v9
v_dot2_f32_bf16 v13, v65, v65, v13
v_dot2_f32_bf16 v8, v66, s40, v8
v_dot2_f32_bf16 v12, v66, v66, v12
v_dot2_f32_bf16 v9, v67, s40, v9
v_dot2_f32_bf16 v13, v67, v67, v13
v_dot2_f32_bf16 v8, v68, s40, v8
v_dot2_f32_bf16 v12, v68, v68, v12
v_dot2_f32_bf16 v9, v69, s40, v9
v_dot2_f32_bf16 v13, v69, v69, v13
v_dot2_f32_bf16 v8, v70, s40, v8
v_dot2_f32_bf16 v12, v70, v70, v12
v_dot2_f32_bf16 v9, v71, s40, v9
v_dot2_f32_bf16 v13, v71, v71, v13
v_dot2_f32_bf16 v8, v72, s40, v8
v_dot2_f32_bf16 v12, v72, v72, v12
v_dot2_f32_bf16 v9, v73, s40, v9
v_dot2_f32_bf16 v13, v73, v73, v13
v_dot2_f32_bf16 v8, v74, s40, v8
v_dot2_f32_bf16 v12, v74, v74, v12
v_dot2_f32_bf16 v9, v75, s40, v9
v_dot2_f32_bf16 v13, v75, v75, v13
v_dot2_f32_bf16 v8, v76, s40, v8
v_dot2_f32_bf16 v12, v76, v76, v12
v_dot2_f32_bf16 v9, v77, s40, v9
v_dot2_f32_bf16 v13, v77, v77, v13
v_dot2_f32_bf16 v8, v78, s40, v8
v_dot2_f32_bf16 v12, v78, v78, v12
v_dot2_f32_bf16 v9, v79, s40, v9
v_dot2_f32_bf16 v13, v79, v79, v13
s_waitcnt vmcnt(6)
v_dot2_f32_bf16 v8, v80, s40, v8
v_dot2_f32_bf16 v12, v80, v80, v12
v_dot2_f32_bf16 v9, v81, s40, v9
v_dot2_f32_bf16 v13, v81, v81, v13
v_dot2_f32_bf16 v8, v82, s40, v8
v_dot2_f32_bf16 v12, v82, v82, v12
v_dot2_f32_bf16 v9, v83, s40, v9
v_dot2_f32_bf16 v13, v83, v83, v13
v_dot2_f32_bf16 v8, v84, s40, v8
v_dot2_f32_bf16 v12, v84, v84, v12
v_dot2_f32_bf16 v9, v85, s40, v9
v_dot2_f32_bf16 v13, v85, v85, v13
v_dot2_f32_bf16 v8, v86, s40, v8
v_dot2_f32_bf16 v12, v86, v86, v12
v_dot2_f32_bf16 v9, v87, s40, v9
v_dot2_f32_bf16 v13, v87, v87, v13
v_dot2_f32_bf16 v8, v88, s40, v8
v_dot2_f32_bf16 v12, v88, v88, v12
v_dot2_f32_bf16 v9, v89, s40, v9
v_dot2_f32_bf16 v13, v89, v89, v13
v_dot2_f32_bf16 v8, v90, s40, v8
v_dot2_f32_bf16 v12, v90, v90, v12
v_dot2_f32_bf16 v9, v91, s40, v9
v_dot2_f32_bf16 v13, v91, v91, v13
v_dot2_f32_bf16 v8, v92, s40, v8
v_dot2_f32_bf16 v12, v92, v92, v12
v_dot2_f32_bf16 v9, v93, s40, v9
v_dot2_f32_bf16 v13, v93, v93, v13
v_dot2_f32_bf16 v8, v94, s40, v8
v_dot2_f32_bf16 v12, v94, v94, v12
v_dot2_f32_bf16 v9, v95, s40, v9
v_dot2_f32_bf16 v13, v95, v95, v13
s_waitcnt vmcnt(2)
v_dot2_f32_bf16 v8, v96, s40, v8
v_dot2_f32_bf16 v12, v96, v96, v12
v_dot2_f32_bf16 v9, v97, s40, v9
v_dot2_f32_bf16 v13, v97, v97, v13
v_dot2_f32_bf16 v8, v98, s40, v8
v_dot2_f32_bf16 v12, v98, v98, v12
v_dot2_f32_bf16 v9, v99, s40, v9
v_dot2_f32_bf16 v13, v99, v99, v13
v_dot2_f32_bf16 v8, v100, s40, v8
v_dot2_f32_bf16 v12, v100, v100, v12
v_dot2_f32_bf16 v9, v101, s40, v9
v_dot2_f32_bf16 v13, v101, v101, v13
v_dot2_f32_bf16 v8, v102, s40, v8
v_dot2_f32_bf16 v12, v102, v102, v12
v_dot2_f32_bf16 v9, v103, s40, v9
v_dot2_f32_bf16 v13, v103, v103, v13
v_dot2_f32_bf16 v8, v104, s40, v8
v_dot2_f32_bf16 v12, v104, v104, v12
v_dot2_f32_bf16 v9, v105, s40, v9
v_dot2_f32_bf16 v13, v105, v105, v13
v_dot2_f32_bf16 v8, v106, s40, v8
v_dot2_f32_bf16 v12, v106, v106, v12
v_dot2_f32_bf16 v9, v107, s40, v9
v_dot2_f32_bf16 v13, v107, v107, v13
v_dot2_f32_bf16 v8, v108, s40, v8
v_dot2_f32_bf16 v12, v108, v108, v12
v_dot2_f32_bf16 v9, v109, s40, v9
v_dot2_f32_bf16 v13, v109, v109, v13
v_dot2_f32_bf16 v8, v110, s40, v8
v_dot2_f32_bf16 v12, v110, v110, v12
v_dot2_f32_bf16 v9, v111, s40, v9
v_dot2_f32_bf16 v13, v111, v111, v13
s_waitcnt vmcnt(0)
v_dot2_f32_bf16 v8, v112, s40, v8
v_dot2_f32_bf16 v12, v112, v112, v12
v_dot2_f32_bf16 v9, v113, s40, v9
v_dot2_f32_bf16 v13, v113, v113, v13
v_dot2_f32_bf16 v8, v114, s40, v8
v_dot2_f32_bf16 v12, v114, v114, v12
v_dot2_f32_bf16 v9, v115, s40, v9
v_dot2_f32_bf16 v13, v115, v115, v13
v_dot2_f32_bf16 v8, v116, s40, v8
v_dot2_f32_bf16 v12, v116, v116, v12
v_dot2_f32_bf16 v9, v117, s40, v9
v_dot2_f32_bf16 v13, v117, v117, v13
v_dot2_f32_bf16 v8, v118, s40, v8
v_dot2_f32_bf16 v12, v118, v118, v12
v_dot2_f32_bf16 v9, v119, s40, v9
v_dot2_f32_bf16 v13, v119, v119, v13

s_nop 2
v_add_f32 v8, v8, v9
v_add_f32 v12, v12, v13
s_nop 1
v_add_f32_dpp v8, v8, v8 quad_perm:[1,0,3,2] row_mask:0xf bank_mask:0xf
v_add_f32_dpp v12, v12, v12 quad_perm:[1,0,3,2] row_mask:0xf bank_mask:0xf
s_nop 1
v_add_f32_dpp v8, v8, v8 quad_perm:[2,3,0,1] row_mask:0xf bank_mask:0xf
v_add_f32_dpp v12, v12, v12 quad_perm:[2,3,0,1] row_mask:0xf bank_mask:0xf
s_mov_b32 s41, 0x3b124925
s_mov_b32 s42, 0x3727c5ac
v_mul_f32 v8, s41, v8
v_mul_f32 v12, s41, v12
v_fma_f32 v12, -v8, v8, v12
v_max_f32 v12, 0, v12
v_add_f32 v12, s42, v12
v_rsq_f32 v56, v12
s_nop 0
v_mul_f32 v57, v8, v56
v_sub_f32 v57, 0, v57
v_lshlrev_b32 v14, 3, v59
v_cmp_eq_u32 vcc, 0, v58
s_and_saveexec_b64 s[48:49], vcc
buffer_store_dwordx2 v[56:57], v14, s[36:39], 0 offen sc1
s_mov_b64 exec, s[48:49]

s_mov_b32 s32, s70
s_mov_b32 s33, s71
s_mov_b32 s34, 1605632
s_mov_b32 s35, 0x20000
buffer_load_dwordx4 v[128:131], v62, s[32:35], s21 offen
s_add_u32 s21, s21, 3584
buffer_load_dwordx4 v[132:135], v62, s[32:35], s21 offen
s_add_u32 s21, s21, 3584
buffer_load_dwordx4 v[136:139], v62, s[32:35], s21 offen
s_add_u32 s21, s21, 3584
buffer_load_dwordx4 v[140:143], v62, s[32:35], s21 offen
s_add_u32 s21, s21, 3584
buffer_load_dwordx4 v[144:147], v62, s[32:35], s21 offen
s_add_u32 s21, s21, 3584
buffer_load_dwordx4 v[148:151], v62, s[32:35], s21 offen
s_add_u32 s21, s21, 3584
buffer_load_dwordx4 v[152:155], v62, s[32:35], s21 offen
s_add_u32 s21, s21, 3584
buffer_load_dwordx4 v[156:159], v62, s[32:35], s21 offen
s_add_u32 s21, s21, 3584
buffer_load_dwordx4 v[160:163], v62, s[32:35], s21 offen
s_add_u32 s21, s21, 3584
buffer_load_dwordx4 v[164:167], v62, s[32:35], s21 offen
s_add_u32 s21, s21, 3584
buffer_load_dwordx4 v[168:171], v62, s[32:35], s21 offen
s_add_u32 s21, s21, 3584
buffer_load_dwordx4 v[172:175], v62, s[32:35], s21 offen
s_add_u32 s21, s21, 3584
buffer_load_dwordx4 v[176:179], v62, s[32:35], s21 offen
s_add_u32 s21, s21, 3584
buffer_load_dwordx4 v[180:183], v62, s[32:35], s21 offen
s_add_u32 s21, s21, 3584

s_waitcnt vmcnt(14)
s_barrier
v_mov_b32 v16, 0xffff0000

v_mov_b32 v20, 0
v_mov_b32 v21, 0
v_mov_b32 v22, 0
v_mov_b32 v23, 0
v_mov_b32 v24, 0
v_mov_b32 v25, 0
v_mov_b32 v26, 0
v_mov_b32 v27, 0
s_waitcnt vmcnt(0)
v_lshlrev_b32 v18, 16, v128
v_and_b32 v19, v16, v128
v_pk_add_f32 v[20:21], v[20:21], v[18:19]
v_lshlrev_b32 v18, 16, v129
v_and_b32 v19, v16, v129
v_pk_add_f32 v[22:23], v[22:23], v[18:19]
v_lshlrev_b32 v18, 16, v130
v_and_b32 v19, v16, v130
v_pk_add_f32 v[24:25], v[24:25], v[18:19]
v_lshlrev_b32 v18, 16, v131
v_and_b32 v19, v16, v131
v_pk_add_f32 v[26:27], v[26:27], v[18:19]
v_lshlrev_b32 v18, 16, v132
v_and_b32 v19, v16, v132
v_pk_add_f32 v[20:21], v[20:21], v[18:19]
v_lshlrev_b32 v18, 16, v133
v_and_b32 v19, v16, v133
v_pk_add_f32 v[22:23], v[22:23], v[18:19]
v_lshlrev_b32 v18, 16, v134
v_and_b32 v19, v16, v134
v_pk_add_f32 v[24:25], v[24:25], v[18:19]
v_lshlrev_b32 v18, 16, v135
v_and_b32 v19, v16, v135
v_pk_add_f32 v[26:27], v[26:27], v[18:19]
v_lshlrev_b32 v18, 16, v136
v_and_b32 v19, v16, v136
v_pk_add_f32 v[20:21], v[20:21], v[18:19]
v_lshlrev_b32 v18, 16, v137
v_and_b32 v19, v16, v137
v_pk_add_f32 v[22:23], v[22:23], v[18:19]
v_lshlrev_b32 v18, 16, v138
v_and_b32 v19, v16, v138
v_pk_add_f32 v[24:25], v[24:25], v[18:19]
v_lshlrev_b32 v18, 16, v139
v_and_b32 v19, v16, v139
v_pk_add_f32 v[26:27], v[26:27], v[18:19]
v_lshlrev_b32 v18, 16, v140
v_and_b32 v19, v16, v140
v_pk_add_f32 v[20:21], v[20:21], v[18:19]
v_lshlrev_b32 v18, 16, v141
v_and_b32 v19, v16, v141
v_pk_add_f32 v[22:23], v[22:23], v[18:19]
v_lshlrev_b32 v18, 16, v142
v_and_b32 v19, v16, v142
v_pk_add_f32 v[24:25], v[24:25], v[18:19]
v_lshlrev_b32 v18, 16, v143
v_and_b32 v19, v16, v143
v_pk_add_f32 v[26:27], v[26:27], v[18:19]
v_lshlrev_b32 v18, 16, v144
v_and_b32 v19, v16, v144
v_pk_add_f32 v[20:21], v[20:21], v[18:19]
v_lshlrev_b32 v18, 16, v145
v_and_b32 v19, v16, v145
v_pk_add_f32 v[22:23], v[22:23], v[18:19]
v_lshlrev_b32 v18, 16, v146
v_and_b32 v19, v16, v146
v_pk_add_f32 v[24:25], v[24:25], v[18:19]
v_lshlrev_b32 v18, 16, v147
v_and_b32 v19, v16, v147
v_pk_add_f32 v[26:27], v[26:27], v[18:19]
v_lshlrev_b32 v18, 16, v148
v_and_b32 v19, v16, v148
v_pk_add_f32 v[20:21], v[20:21], v[18:19]
v_lshlrev_b32 v18, 16, v149
v_and_b32 v19, v16, v149
v_pk_add_f32 v[22:23], v[22:23], v[18:19]
v_lshlrev_b32 v18, 16, v150
v_and_b32 v19, v16, v150
v_pk_add_f32 v[24:25], v[24:25], v[18:19]
v_lshlrev_b32 v18, 16, v151
v_and_b32 v19, v16, v151
v_pk_add_f32 v[26:27], v[26:27], v[18:19]
v_lshlrev_b32 v18, 16, v152
v_and_b32 v19, v16, v152
v_pk_add_f32 v[20:21], v[20:21], v[18:19]
v_lshlrev_b32 v18, 16, v153
v_and_b32 v19, v16, v153
v_pk_add_f32 v[22:23], v[22:23], v[18:19]
v_lshlrev_b32 v18, 16, v154
v_and_b32 v19, v16, v154
v_pk_add_f32 v[24:25], v[24:25], v[18:19]
v_lshlrev_b32 v18, 16, v155
v_and_b32 v19, v16, v155
v_pk_add_f32 v[26:27], v[26:27], v[18:19]
v_lshlrev_b32 v18, 16, v156
v_and_b32 v19, v16, v156
v_pk_add_f32 v[20:21], v[20:21], v[18:19]
v_lshlrev_b32 v18, 16, v157
v_and_b32 v19, v16, v157
v_pk_add_f32 v[22:23], v[22:23], v[18:19]
v_lshlrev_b32 v18, 16, v158
v_and_b32 v19, v16, v158
v_pk_add_f32 v[24:25], v[24:25], v[18:19]
v_lshlrev_b32 v18, 16, v159
v_and_b32 v19, v16, v159
v_pk_add_f32 v[26:27], v[26:27], v[18:19]
v_lshlrev_b32 v18, 16, v160
v_and_b32 v19, v16, v160
v_pk_add_f32 v[20:21], v[20:21], v[18:19]
v_lshlrev_b32 v18, 16, v161
v_and_b32 v19, v16, v161
v_pk_add_f32 v[22:23], v[22:23], v[18:19]
v_lshlrev_b32 v18, 16, v162
v_and_b32 v19, v16, v162
v_pk_add_f32 v[24:25], v[24:25], v[18:19]
v_lshlrev_b32 v18, 16, v163
v_and_b32 v19, v16, v163
v_pk_add_f32 v[26:27], v[26:27], v[18:19]
v_lshlrev_b32 v18, 16, v164
v_and_b32 v19, v16, v164
v_pk_add_f32 v[20:21], v[20:21], v[18:19]
v_lshlrev_b32 v18, 16, v165
v_and_b32 v19, v16, v165
v_pk_add_f32 v[22:23], v[22:23], v[18:19]
v_lshlrev_b32 v18, 16, v166
v_and_b32 v19, v16, v166
v_pk_add_f32 v[24:25], v[24:25], v[18:19]
v_lshlrev_b32 v18, 16, v167
v_and_b32 v19, v16, v167
v_pk_add_f32 v[26:27], v[26:27], v[18:19]
v_lshlrev_b32 v18, 16, v168
v_and_b32 v19, v16, v168
v_pk_add_f32 v[20:21], v[20:21], v[18:19]
v_lshlrev_b32 v18, 16, v169
v_and_b32 v19, v16, v169
v_pk_add_f32 v[22:23], v[22:23], v[18:19]
v_lshlrev_b32 v18, 16, v170
v_and_b32 v19, v16, v170
v_pk_add_f32 v[24:25], v[24:25], v[18:19]
v_lshlrev_b32 v18, 16, v171
v_and_b32 v19, v16, v171
v_pk_add_f32 v[26:27], v[26:27], v[18:19]
v_lshlrev_b32 v18, 16, v172
v_and_b32 v19, v16, v172
v_pk_add_f32 v[20:21], v[20:21], v[18:19]
v_lshlrev_b32 v18, 16, v173
v_and_b32 v19, v16, v173
v_pk_add_f32 v[22:23], v[22:23], v[18:19]
v_lshlrev_b32 v18, 16, v174
v_and_b32 v19, v16, v174
v_pk_add_f32 v[24:25], v[24:25], v[18:19]
v_lshlrev_b32 v18, 16, v175
v_and_b32 v19, v16, v175
v_pk_add_f32 v[26:27], v[26:27], v[18:19]
v_lshlrev_b32 v18, 16, v176
v_and_b32 v19, v16, v176
v_pk_add_f32 v[20:21], v[20:21], v[18:19]
v_lshlrev_b32 v18, 16, v177
v_and_b32 v19, v16, v177
v_pk_add_f32 v[22:23], v[22:23], v[18:19]
v_lshlrev_b32 v18, 16, v178
v_and_b32 v19, v16, v178
v_pk_add_f32 v[24:25], v[24:25], v[18:19]
v_lshlrev_b32 v18, 16, v179
v_and_b32 v19, v16, v179
v_pk_add_f32 v[26:27], v[26:27], v[18:19]
v_lshlrev_b32 v18, 16, v180
v_and_b32 v19, v16, v180
v_pk_add_f32 v[20:21], v[20:21], v[18:19]
v_lshlrev_b32 v18, 16, v181
v_and_b32 v19, v16, v181
v_pk_add_f32 v[22:23], v[22:23], v[18:19]
v_lshlrev_b32 v18, 16, v182
v_and_b32 v19, v16, v182
v_pk_add_f32 v[24:25], v[24:25], v[18:19]
v_lshlrev_b32 v18, 16, v183
v_and_b32 v19, v16, v183
v_pk_add_f32 v[26:27], v[26:27], v[18:19]
s_nop 1
v_add_f32_dpp v20, v20, v20 row_ror:8 row_mask:0xf bank_mask:0xf
v_add_f32_dpp v21, v21, v21 row_ror:8 row_mask:0xf bank_mask:0xf
v_add_f32_dpp v22, v22, v22 row_ror:8 row_mask:0xf bank_mask:0xf
v_add_f32_dpp v23, v23, v23 row_ror:8 row_mask:0xf bank_mask:0xf
v_add_f32_dpp v24, v24, v24 row_ror:8 row_mask:0xf bank_mask:0xf
v_add_f32_dpp v25, v25, v25 row_ror:8 row_mask:0xf bank_mask:0xf
v_add_f32_dpp v26, v26, v26 row_ror:8 row_mask:0xf bank_mask:0xf
v_add_f32_dpp v27, v27, v27 row_ror:8 row_mask:0xf bank_mask:0xf

v_lshrrev_b32 v5, 4, v0
v_lshlrev_b32 v5, 8, v5
v_lshl_add_u32 v5, v61, 5, v5
v_and_b32 v6, 8, v0
v_cmp_eq_u32 vcc, 0, v6
s_and_saveexec_b64 s[48:49], vcc
ds_write_b128 v5, v[20:23]
ds_write_b128 v5, v[24:27] offset:16
s_mov_b64 exec, s[48:49]
s_waitcnt lgkmcnt(0)
s_barrier
v_lshlrev_b32 v5, 2, v0

ds_read_b32 v30, v5 offset:0
ds_read_b32 v31, v5 offset:256
ds_read_b32 v32, v5 offset:512
ds_read_b32 v33, v5 offset:768
ds_read_b32 v34, v5 offset:1024
ds_read_b32 v35, v5 offset:1280
ds_read_b32 v36, v5 offset:1536
ds_read_b32 v37, v5 offset:1792
ds_read_b32 v38, v5 offset:2048
ds_read_b32 v39, v5 offset:2304
ds_read_b32 v40, v5 offset:2560
ds_read_b32 v41, v5 offset:2816
ds_read_b32 v42, v5 offset:3072
ds_read_b32 v43, v5 offset:3328
ds_read_b32 v44, v5 offset:3584
ds_read_b32 v45, v5 offset:3840
s_waitcnt lgkmcnt(0)
v_add_f32 v30, v30, v31
v_add_f32 v30, v30, v32
v_add_f32 v30, v30, v33
v_add_f32 v30, v30, v34
v_add_f32 v30, v30, v35
v_add_f32 v30, v30, v36
v_add_f32 v30, v30, v37
v_add_f32 v30, v30, v38
v_add_f32 v30, v30, v39
v_add_f32 v30, v30, v40
v_add_f32 v30, v30, v41
v_add_f32 v30, v30, v42
v_add_f32 v30, v30, v43
v_add_f32 v30, v30, v44
v_add_f32 v30, v30, v45
s_add_u32 s32, s12, 4259840
s_addc_u32 s33, s13, 0
s_mov_b32 s34, 7168
s_mov_b32 s35, 0x20000

s_lshl_b32 s18, s19, 8
v_cmp_gt_u32 vcc, 64, v0
s_and_saveexec_b64 s[48:49], vcc
s_cbranch_execz conv_kernel_done
buffer_store_dword v30, v5, s[32:35], s18 offen
s_branch conv_kernel_done
conv_kernel_sph:
s_waitcnt lgkmcnt(0)
s_mov_b32 s12, s78
s_mov_b32 s13, s79
s_mov_b32 s56, s76
s_mov_b32 s57, s77
s_mov_b32 s58, 256
s_mov_b32 s59, 0x20000

s_add_u32 s44, s12, 4587520
s_addc_u32 s45, s13, 0
s_mov_b32 s46, 32768
s_mov_b32 s47, 0x20000
v_mov_b32 v31, 0
s_mov_b32 s60, 0
conv_kernel_nps:
buffer_load_dword v29, v31, s[56:59], 0 offen sc1
s_waitcnt vmcnt(0)
v_readfirstlane_b32 s61, v29
s_cmp_lg_u32 s61, 0
s_cbranch_scc1 conv_kernel_npxs
s_add_u32 s60, s60, 1
s_cmp_gt_u32 s60, 0x100000
s_cbranch_scc1 conv_kernel_npxs
s_sleep 2
s_branch conv_kernel_nps
conv_kernel_npxs:

s_barrier
v_mov_b32 v28, s61
s_lshl_b32 s50, s15, 6
s_add_u32 s50, s50, 30720
s_mov_b64 exec, 1
buffer_store_dword v28, v31, s[44:47], s50 offen sc1
s_mov_b64 exec, -1
s_add_u32 s52, s12, 8388608
s_addc_u32 s53, s13, 0
s_mov_b32 s54, 7340032
s_mov_b32 s55, 0x20000
s_mul_i32 s56, s15, 28672
s_add_u32 s56, s56, 6422528
v_lshlrev_b32 v30, 4, v144
s_barrier

v_lshlrev_b32 v31, 7, v144
conv_kernel_done:
s_endpgm
.text
.globl ffn_kernel
.p2align 8
.type ffn_kernel,@function
ffn_kernel:

s_load_dwordx4 s[4:7], s[0:1], 56
s_load_dwordx4 s[72:75], s[0:1], 80
s_load_dwordx2 s[12:13], s[0:1], 104
s_cmp_ge_u32 s2, 256
s_cbranch_scc1 ffn_kernel_done
s_and_b32 s16, s2, 7
s_lshr_b32 s17, s2, 3
s_cmp_ge_u32 s17, 28
s_cbranch_scc1 ffn_kernel_pf
s_mul_i32 s18, s17, 37
s_lshr_b32 s18, s18, 8
s_mul_i32 s19, s18, 7
s_sub_u32 s15, s17, s19
s_lshl_b32 s14, s16, 2
s_add_u32 s14, s14, s18
v_lshrrev_b32 v6, 6, v0
s_nop 0
v_readfirstlane_b32 s71, v6

v_lshrrev_b32 v6, 6, v0
v_and_b32 v1, 63, v0
v_readfirstlane_b32 s20, v6
v_lshrrev_b32 v2, 3, v1
v_and_b32 v3, 7, v1
v_bfe_u32 v6, v1, 4, 1
v_lshlrev_b32 v6, 2, v6
v_xor_b32 v3, v3, v6
v_lshlrev_b32 v3, 4, v3
v_bfe_u32 v7, v1, 2, 2
s_and_b32 s70, s71, 1
s_lshl_b32 s70, s70, 1
v_xor_b32 v7, s70, v7
v_lshrrev_b32 v6, 5, v1
v_lshl_add_u32 v6, v6, 2, v7
v_lshlrev_b32 v4, 7, v6
v_lshrrev_b32 v7, 1, v7
v_lshl_add_u32 v4, v7, 6, v4
v_bfe_u32 v7, v1, 4, 1
v_lshl_add_u32 v4, v7, 5, v4
v_and_b32 v7, 3, v1
v_lshl_add_u32 v4, v7, 3, v4

s_lshr_b32 s70, s71, 1
s_lshl_b32 s70, s70, 10
v_add_u32 v4, s70, v4
v_xor_b32 v6, 1024, v4
v_xor_b32 v5, 64, v4
v_xor_b32 v7, 64, v6

v_lshlrev_b32 v10, 12, v2
v_add_u32 v10, v10, v3
s_movk_i32 s21, 3584
v_mul_lo_u32 v8, v2, s21
v_add_u32 v8, v8, v3
v_add_u32 v60, 27648, v8
s_lshl_b32 s21, s14, 7
s_lshl_b32 s22, s20, 15
s_add_u32 s21, s21, s22
s_lshl_b32 s23, s20, 10
s_lshl_b32 s45, s15, 2
s_add_u32 s45, s45, s20
s_lshl_b32 s44, s45, 7
s_mul_i32 s47, s20, 14336
s_add_u32 s47, s47, 61440
s_mov_b32 m0, s23
s_mov_b32 s34, 1835008
s_mov_b32 s35, 0x20000
s_mov_b32 s26, 1605632
s_mov_b32 s27, 0x20000

v_mov_b32 v64, 0
v_mov_b32 v65, 0
v_mov_b32 v66, 0
v_mov_b32 v67, 0
v_mov_b32 v68, 0
v_mov_b32 v69, 0
v_mov_b32 v70, 0
v_mov_b32 v71, 0
v_mov_b32 v72, 0
v_mov_b32 v73, 0
v_mov_b32 v74, 0
v_mov_b32 v75, 0
v_mov_b32 v76, 0
v_mov_b32 v77, 0
v_mov_b32 v78, 0
v_mov_b32 v79, 0
v_mov_b32 v80, 0
v_mov_b32 v81, 0
v_mov_b32 v82, 0
v_mov_b32 v83, 0
v_mov_b32 v84, 0
v_mov_b32 v85, 0
v_mov_b32 v86, 0
v_mov_b32 v87, 0
v_mov_b32 v88, 0
v_mov_b32 v89, 0
v_mov_b32 v90, 0
v_mov_b32 v91, 0
v_mov_b32 v92, 0
v_mov_b32 v93, 0
v_mov_b32 v94, 0
v_mov_b32 v95, 0
v_mov_b32 v96, 0
v_mov_b32 v97, 0
v_mov_b32 v98, 0
v_mov_b32 v99, 0
v_mov_b32 v100, 0
v_mov_b32 v101, 0
v_mov_b32 v102, 0
v_mov_b32 v103, 0
v_mov_b32 v104, 0
v_mov_b32 v105, 0
v_mov_b32 v106, 0
v_mov_b32 v107, 0
v_mov_b32 v108, 0
v_mov_b32 v109, 0
v_mov_b32 v110, 0
v_mov_b32 v111, 0
v_mov_b32 v112, 0
v_mov_b32 v113, 0
v_mov_b32 v114, 0
v_mov_b32 v115, 0
v_mov_b32 v116, 0
v_mov_b32 v117, 0
v_mov_b32 v118, 0
v_mov_b32 v119, 0
v_mov_b32 v120, 0
v_mov_b32 v121, 0
v_mov_b32 v122, 0
v_mov_b32 v123, 0
v_mov_b32 v124, 0
v_mov_b32 v125, 0
v_mov_b32 v126, 0
v_mov_b32 v127, 0

s_waitcnt lgkmcnt(0)
s_add_u32 s32, s12, 5242880
s_addc_u32 s33, s13, 0
s_mov_b32 s24, s4
s_mov_b32 s25, s5

buffer_load_dwordx4 v10, s[32:35], s21 offen lds
s_add_u32 s21, s21, 131072
s_add_u32 m0, m0, 4096
v_add_u32 v56, s47, v4
v_add_u32 v57, s47, v5
v_add_u32 v58, s47, v6
buffer_load_dwordx4 v10, s[32:35], s21 offen lds
s_add_u32 s21, s21, 131072
s_add_u32 m0, m0, 4096
v_add_u32 v59, s47, v7
v_lshlrev_b32 v16, 4, v1
v_add_u32 v17, 4096, v16
buffer_load_dwordx4 v10, s[32:35], s21 offen lds
s_add_u32 s21, s21, 131072
s_add_u32 m0, m0, 4096
v_add_u32 v18, 8192, v16
v_add_u32 v19, 12288, v16
s_mul_i32 s46, s15, 229376
buffer_load_dwordx4 v10, s[32:35], s21 offen lds
s_add_u32 s21, s21, 131072
s_add_u32 m0, m0, 4096
s_mul_i32 s49, s20, 57344
s_add_u32 s46, s46, s49
s_mov_b32 s28, s6
buffer_load_dwordx4 v10, s[32:35], s21 offen lds
s_add_u32 s21, s21, 131072
s_add_u32 m0, m0, 4096
s_mov_b32 s29, s7
s_movk_i32 s30, 3584
s_mov_b32 s31, 0x20000
buffer_load_dwordx4 v10, s[32:35], s21 offen lds
s_add_u32 s21, s21, 131072
s_add_u32 m0, m0, 4096
s_add_u32 s40, s12, 4259840
s_addc_u32 s41, s13, 0
s_movk_i32 s42, 7168
s_mov_b32 s43, 0x20000
buffer_load_dwordx4 v10, s[32:35], s21 offen lds
s_add_u32 s21, s21, 131072
s_add_u32 m0, m0, 4096
s_mov_b32 s36, s12
s_mov_b32 s37, s13
s_mov_b32 s38, 15728640
buffer_load_dwordx4 v10, s[32:35], s21 offen lds
s_add_u32 s21, s21, 131072
s_add_u32 m0, m0, 4096
s_mov_b32 s39, 0x20000
s_add_u32 s52, s12, 4325376
s_addc_u32 s53, s13, 0
s_mov_b32 s54, 229376
buffer_load_dwordx4 v10, s[32:35], s21 offen lds
s_add_u32 s21, s21, 131072
s_add_u32 m0, m0, 4096
s_mov_b32 s55, 0x20000
s_add_u32 s4, s12, 18382848
s_addc_u32 s5, s13, 0
s_mov_b32 s6, 1605632
buffer_load_dwordx4 v10, s[32:35], s21 offen lds
s_add_u32 s21, s21, 131072
s_add_u32 m0, m0, 4096
s_mov_b32 s7, 0x20000
s_getreg_b32 s76, hwreg(HW_REG_XCC_ID)
s_and_b32 s76, s76, 15
buffer_load_dwordx4 v10, s[32:35], s21 offen lds
s_add_u32 s21, s21, 131072
s_add_u32 m0, m0, 4096
s_add_u32 s76, s76, 16
s_mul_i32 s77, s14, 7
s_add_u32 s78, s77, s15
buffer_load_dwordx4 v10, s[32:35], s21 offen lds
s_add_u32 s21, s21, 131072
s_add_u32 m0, m0, 4096
s_lshl_b32 s78, s78, 6
s_add_u32 s78, s78, 122880
s_lshl_b32 s77, s77, 6
buffer_load_dwordx4 v10, s[32:35], s21 offen lds
s_add_u32 s21, s21, 131072
s_add_u32 m0, m0, 4096
s_add_u32 s77, s77, 122880
v_mov_b32 v25, s76
v_mov_b32 v26, 0
buffer_load_dwordx4 v10, s[32:35], s21 offen lds
s_add_u32 s21, s21, 131072
s_mov_b32 m0, s47
v_and_b32 v20, 31, v1
s_lshl_b32 s50, s45, 6
v_add_u32 v20, s50, v20
buffer_load_dwordx4 v8, s[24:27], s44 offen lds
buffer_load_dwordx4 v60, s[24:27], s44 offen offset:1024 lds
s_add_u32 s44, s44, 57344
s_add_u32 m0, m0, 2048
v_lshlrev_b32 v21, 2, v20
v_lshlrev_b32 v22, 1, v20
v_lshlrev_b32 v27, 6, v1
buffer_load_dwordx4 v8, s[24:27], s44 offen lds
buffer_load_dwordx4 v60, s[24:27], s44 offen offset:1024 lds
s_add_u32 s44, s44, 57344
s_add_u32 m0, m0, 2048
v_mov_b32 v12, 0
v_mov_b32 v13, 0
v_mov_b32 v14, 0
buffer_load_dwordx4 v8, s[24:27], s44 offen lds
buffer_load_dwordx4 v60, s[24:27], s44 offen offset:1024 lds
s_add_u32 s44, s44, 57344
s_add_u32 m0, m0, 2048
v_mov_b32 v15, 0
v_mov_b32 v38, 0xffff0000
s_nop 0
buffer_load_dwordx4 v8, s[24:27], s44 offen lds
buffer_load_dwordx4 v60, s[24:27], s44 offen offset:1024 lds
s_add_u32 s44, s44, 57344
s_add_u32 m0, m0, 2048
s_nop 0
buffer_load_dwordx4 v8, s[24:27], s44 offen lds
buffer_load_dwordx4 v60, s[24:27], s44 offen offset:1024 lds
s_add_u32 s44, s44, 57344
s_add_u32 m0, m0, 2048
s_nop 0
buffer_load_dwordx4 v8, s[24:27], s44 offen lds
buffer_load_dwordx4 v60, s[24:27], s44 offen offset:1024 lds
s_add_u32 s44, s44, 57344
s_add_u32 m0, m0, 2048
s_nop 0
buffer_load_dwordx4 v8, s[24:27], s44 offen lds
buffer_load_dwordx4 v60, s[24:27], s44 offen offset:1024 lds
s_add_u32 s44, s44, 57344
s_add_u32 m0, m0, 2048
s_nop 0

s_cmp_lg_u32 s20, 0
s_cbranch_scc1 ffn_kernel_noxid
s_mov_b64 exec, 1
buffer_store_dword v25, v26, s[52:55], s78 offen sc1
s_mov_b64 exec, -1
ffn_kernel_noxid:
buffer_load_dword v248, v21, s[40:43], 0 offen
buffer_load_dword v249, v21, s[40:43], 0 offen offset:128
buffer_load_ushort v242, v22, s[28:31], 0 offen
buffer_load_ushort v246, v22, s[28:31], 0 offen offset:64

s_waitcnt vmcnt(16)
s_barrier
ds_read_b64_tr_b16 v[184:185], v56 offset:0
ds_read_b64_tr_b16 v[186:187], v58 offset:0
ds_read_b64_tr_b16 v[188:189], v57 offset:0
ds_read_b64_tr_b16 v[190:191], v59 offset:0
ds_read_b64_tr_b16 v[128:129], v4 offset:0
ds_read_b64_tr_b16 v[130:131], v6 offset:0
ds_read_b64_tr_b16 v[132:133], v5 offset:0
ds_read_b64_tr_b16 v[134:135], v7 offset:0
ds_read_b64_tr_b16 v[136:137], v4 offset:2048
ds_read_b64_tr_b16 v[138:139], v6 offset:2048
ds_read_b64_tr_b16 v[140:141], v5 offset:2048
ds_read_b64_tr_b16 v[142:143], v7 offset:2048
s_mov_b32 s48, 0
ffn_kernel_g1:
s_waitcnt vmcnt(10) lgkmcnt(4)
v_mfma_f32_32x32x16_bf16 v[64:79], v[184:187], v[128:131], v[64:79]
ds_read_b64_tr_b16 v[192:193], v56 offset:2048
ds_read_b64_tr_b16 v[194:195], v58 offset:2048
s_add_u32 m0, s47, 0
v_lshlrev_b32 v40, 16, v128
v_and_b32 v41, v38, v128
v_lshlrev_b32 v42, 16, v132
v_mfma_f32_32x32x16_bf16 v[80:95], v[184:187], v[132:135], v[80:95]
ds_read_b64_tr_b16 v[196:197], v57 offset:2048
ds_read_b64_tr_b16 v[198:199], v59 offset:2048
buffer_load_dwordx4 v8, s[24:27], s44 offen lds
v_and_b32 v43, v38, v132
v_add_f32 v12, v12, v40
v_fmac_f32 v13, v40, v40
v_mfma_f32_32x32x16_bf16 v[96:111], v[188:191], v[128:131], v[96:111]
ds_read_b64_tr_b16 v[144:145], v4 offset:4096
ds_read_b64_tr_b16 v[146:147], v6 offset:4096
buffer_load_dwordx4 v60, s[24:27], s44 offen offset:1024 lds
s_add_u32 s44, s44, 57344
v_add_f32 v14, v14, v42
v_fmac_f32 v15, v42, v42
v_add_f32 v12, v12, v41
v_mfma_f32_32x32x16_bf16 v[112:127], v[188:191], v[132:135], v[112:127]
ds_read_b64_tr_b16 v[148:149], v5 offset:4096
ds_read_b64_tr_b16 v[150:151], v7 offset:4096
v_fmac_f32 v13, v41, v41
v_add_f32 v14, v14, v43
v_fmac_f32 v15, v43, v43
s_waitcnt vmcnt(10) lgkmcnt(4)
v_mfma_f32_32x32x16_bf16 v[64:79], v[192:195], v[136:139], v[64:79]
ds_read_b64_tr_b16 v[200:201], v56 offset:4096
ds_read_b64_tr_b16 v[202:203], v58 offset:4096
s_add_u32 m0, s47, 2048
v_lshlrev_b32 v40, 16, v136
v_and_b32 v41, v38, v136
v_lshlrev_b32 v42, 16, v140
v_mfma_f32_32x32x16_bf16 v[80:95], v[192:195], v[140:143], v[80:95]
ds_read_b64_tr_b16 v[204:205], v57 offset:4096
ds_read_b64_tr_b16 v[206:207], v59 offset:4096
buffer_load_dwordx4 v8, s[24:27], s44 offen lds
v_and_b32 v43, v38, v140
v_add_f32 v12, v12, v40
v_fmac_f32 v13, v40, v40
v_mfma_f32_32x32x16_bf16 v[96:111], v[196:199], v[136:139], v[96:111]
ds_read_b64_tr_b16 v[152:153], v4 offset:6144
ds_read_b64_tr_b16 v[154:155], v6 offset:6144
buffer_load_dwordx4 v60, s[24:27], s44 offen offset:1024 lds
s_add_u32 s44, s44, 57344
v_add_f32 v14, v14, v42
v_fmac_f32 v15, v42, v42
v_add_f32 v12, v12, v41
v_mfma_f32_32x32x16_bf16 v[112:127], v[196:199], v[140:143], v[112:127]
ds_read_b64_tr_b16 v[156:157], v5 offset:6144
ds_read_b64_tr_b16 v[158:159], v7 offset:6144
v_fmac_f32 v13, v41, v41
v_add_f32 v14, v14, v43
v_fmac_f32 v15, v43, v43
s_waitcnt vmcnt(10) lgkmcnt(4)
v_mfma_f32_32x32x16_bf16 v[64:79], v[200:203], v[144:147], v[64:79]
ds_read_b64_tr_b16 v[208:209], v56 offset:6144
ds_read_b64_tr_b16 v[210:211], v58 offset:6144
s_add_u32 m0, s47, 4096
v_lshlrev_b32 v40, 16, v144
v_and_b32 v41, v38, v144
v_lshlrev_b32 v42, 16, v148
v_mfma_f32_32x32x16_bf16 v[80:95], v[200:203], v[148:151], v[80:95]
ds_read_b64_tr_b16 v[212:213], v57 offset:6144
ds_read_b64_tr_b16 v[214:215], v59 offset:6144
buffer_load_dwordx4 v8, s[24:27], s44 offen lds
v_and_b32 v43, v38, v148
v_add_f32 v12, v12, v40
v_fmac_f32 v13, v40, v40
v_mfma_f32_32x32x16_bf16 v[96:111], v[204:207], v[144:147], v[96:111]
ds_read_b64_tr_b16 v[160:161], v4 offset:8192
ds_read_b64_tr_b16 v[162:163], v6 offset:8192
buffer_load_dwordx4 v60, s[24:27], s44 offen offset:1024 lds
s_add_u32 s44, s44, 57344
v_add_f32 v14, v14, v42
v_fmac_f32 v15, v42, v42
v_add_f32 v12, v12, v41
v_mfma_f32_32x32x16_bf16 v[112:127], v[204:207], v[148:151], v[112:127]
ds_read_b64_tr_b16 v[164:165], v5 offset:8192
ds_read_b64_tr_b16 v[166:167], v7 offset:8192
v_fmac_f32 v13, v41, v41
v_add_f32 v14, v14, v43
v_fmac_f32 v15, v43, v43
s_waitcnt vmcnt(10) lgkmcnt(4)
v_mfma_f32_32x32x16_bf16 v[64:79], v[208:211], v[152:155], v[64:79]
ds_read_b64_tr_b16 v[216:217], v56 offset:8192
ds_read_b64_tr_b16 v[218:219], v58 offset:8192
s_add_u32 m0, s47, 6144
v_lshlrev_b32 v40, 16, v152
v_and_b32 v41, v38, v152
v_lshlrev_b32 v42, 16, v156
v_mfma_f32_32x32x16_bf16 v[80:95], v[208:211], v[156:159], v[80:95]
ds_read_b64_tr_b16 v[220:221], v57 offset:8192
ds_read_b64_tr_b16 v[222:223], v59 offset:8192
buffer_load_dwordx4 v8, s[24:27], s44 offen lds
v_and_b32 v43, v38, v156
v_add_f32 v12, v12, v40
v_fmac_f32 v13, v40, v40
v_mfma_f32_32x32x16_bf16 v[96:111], v[212:215], v[152:155], v[96:111]
ds_read_b64_tr_b16 v[168:169], v4 offset:10240
ds_read_b64_tr_b16 v[170:171], v6 offset:10240
buffer_load_dwordx4 v60, s[24:27], s44 offen offset:1024 lds
s_add_u32 s44, s44, 57344
v_add_f32 v14, v14, v42
v_fmac_f32 v15, v42, v42
v_add_f32 v12, v12, v41
v_mfma_f32_32x32x16_bf16 v[112:127], v[212:215], v[156:159], v[112:127]
ds_read_b64_tr_b16 v[172:173], v5 offset:10240
ds_read_b64_tr_b16 v[174:175], v7 offset:10240
v_fmac_f32 v13, v41, v41
v_add_f32 v14, v14, v43
v_fmac_f32 v15, v43, v43
s_waitcnt vmcnt(10) lgkmcnt(4)
v_mfma_f32_32x32x16_bf16 v[64:79], v[216:219], v[160:163], v[64:79]
ds_read_b64_tr_b16 v[224:225], v56 offset:10240
ds_read_b64_tr_b16 v[226:227], v58 offset:10240
s_add_u32 m0, s47, 8192
v_lshlrev_b32 v40, 16, v160
v_and_b32 v41, v38, v160
v_lshlrev_b32 v42, 16, v164
v_mfma_f32_32x32x16_bf16 v[80:95], v[216:219], v[164:167], v[80:95]
ds_read_b64_tr_b16 v[228:229], v57 offset:10240
ds_read_b64_tr_b16 v[230:231], v59 offset:10240
buffer_load_dwordx4 v8, s[24:27], s44 offen lds
v_and_b32 v43, v38, v164
v_add_f32 v12, v12, v40
v_fmac_f32 v13, v40, v40
v_mfma_f32_32x32x16_bf16 v[96:111], v[220:223], v[160:163], v[96:111]
ds_read_b64_tr_b16 v[176:177], v4 offset:12288
ds_read_b64_tr_b16 v[178:179], v6 offset:12288
buffer_load_dwordx4 v60, s[24:27], s44 offen offset:1024 lds
s_add_u32 s44, s44, 57344
v_add_f32 v14, v14, v42
v_fmac_f32 v15, v42, v42
v_add_f32 v12, v12, v41
v_mfma_f32_32x32x16_bf16 v[112:127], v[220:223], v[164:167], v[112:127]
ds_read_b64_tr_b16 v[180:181], v5 offset:12288
ds_read_b64_tr_b16 v[182:183], v7 offset:12288
v_fmac_f32 v13, v41, v41
v_add_f32 v14, v14, v43
v_fmac_f32 v15, v43, v43
s_waitcnt vmcnt(10) lgkmcnt(4)
v_mfma_f32_32x32x16_bf16 v[64:79], v[224:227], v[168:171], v[64:79]
ds_read_b64_tr_b16 v[232:233], v56 offset:12288
ds_read_b64_tr_b16 v[234:235], v58 offset:12288
s_add_u32 m0, s47, 10240
v_lshlrev_b32 v40, 16, v168
v_and_b32 v41, v38, v168
v_lshlrev_b32 v42, 16, v172
v_mfma_f32_32x32x16_bf16 v[80:95], v[224:227], v[172:175], v[80:95]
ds_read_b64_tr_b16 v[236:237], v57 offset:12288
ds_read_b64_tr_b16 v[238:239], v59 offset:12288
buffer_load_dwordx4 v8, s[24:27], s44 offen lds
v_and_b32 v43, v38, v172
v_add_f32 v12, v12, v40
v_fmac_f32 v13, v40, v40
v_mfma_f32_32x32x16_bf16 v[96:111], v[228:231], v[168:171], v[96:111]
ds_read_b64_tr_b16 v[128:129], v4 offset:14336
ds_read_b64_tr_b16 v[130:131], v6 offset:14336
buffer_load_dwordx4 v60, s[24:27], s44 offen offset:1024 lds
s_add_u32 s44, s44, 57344
v_add_f32 v14, v14, v42
v_fmac_f32 v15, v42, v42
v_add_f32 v12, v12, v41
v_mfma_f32_32x32x16_bf16 v[112:127], v[228:231], v[172:175], v[112:127]
ds_read_b64_tr_b16 v[132:133], v5 offset:14336
ds_read_b64_tr_b16 v[134:135], v7 offset:14336
v_fmac_f32 v13, v41, v41
v_add_f32 v14, v14, v43
v_fmac_f32 v15, v43, v43
s_waitcnt vmcnt(10) lgkmcnt(4)
v_mfma_f32_32x32x16_bf16 v[64:79], v[232:235], v[176:179], v[64:79]
ds_read_b64_tr_b16 v[184:185], v56 offset:0
ds_read_b64_tr_b16 v[186:187], v58 offset:0
s_add_u32 m0, s47, 12288
v_lshlrev_b32 v40, 16, v176
v_and_b32 v41, v38, v176
v_lshlrev_b32 v42, 16, v180
v_mfma_f32_32x32x16_bf16 v[80:95], v[232:235], v[180:183], v[80:95]
ds_read_b64_tr_b16 v[188:189], v57 offset:0
ds_read_b64_tr_b16 v[190:191], v59 offset:0
buffer_load_dwordx4 v8, s[24:27], s44 offen lds
v_and_b32 v43, v38, v180
v_add_f32 v12, v12, v40
v_fmac_f32 v13, v40, v40
v_mfma_f32_32x32x16_bf16 v[96:111], v[236:239], v[176:179], v[96:111]
ds_read_b64_tr_b16 v[136:137], v4 offset:16384
ds_read_b64_tr_b16 v[138:139], v6 offset:16384
buffer_load_dwordx4 v60, s[24:27], s44 offen offset:1024 lds
s_add_u32 s44, s44, 57344
v_add_f32 v14, v14, v42
v_fmac_f32 v15, v42, v42
v_add_f32 v12, v12, v41
v_mfma_f32_32x32x16_bf16 v[112:127], v[236:239], v[180:183], v[112:127]
ds_read_b64_tr_b16 v[140:141], v5 offset:16384
ds_read_b64_tr_b16 v[142:143], v7 offset:16384
v_fmac_f32 v13, v41, v41
v_add_f32 v14, v14, v43
v_fmac_f32 v15, v43, v43

s_add_u32 s48, s48, 1
v_add_u32 v4, 14336, v4
v_add_u32 v5, 14336, v5
v_add_u32 v6, 14336, v6
v_add_u32 v7, 14336, v7
s_cmp_lt_u32 s48, 3
s_cbranch_scc1 ffn_kernel_g1

s_waitcnt vmcnt(10) lgkmcnt(4)
v_mfma_f32_32x32x16_bf16 v[64:79], v[184:187], v[128:131], v[64:79]
ds_read_b64_tr_b16 v[192:193], v56 offset:2048
ds_read_b64_tr_b16 v[194:195], v58 offset:2048
v_lshlrev_b32 v40, 16, v128
v_and_b32 v41, v38, v128
v_lshlrev_b32 v42, 16, v132
v_mfma_f32_32x32x16_bf16 v[80:95], v[184:187], v[132:135], v[80:95]
ds_read_b64_tr_b16 v[196:197], v57 offset:2048
ds_read_b64_tr_b16 v[198:199], v59 offset:2048
buffer_load_dwordx4 a[0:3], v16, s[4:7], s46 offen offset:0
v_and_b32 v43, v38, v132
v_add_f32 v12, v12, v40
v_fmac_f32 v13, v40, v40
v_mfma_f32_32x32x16_bf16 v[96:111], v[188:191], v[128:131], v[96:111]
ds_read_b64_tr_b16 v[144:145], v4 offset:4096
ds_read_b64_tr_b16 v[146:147], v6 offset:4096
buffer_load_dwordx4 a[4:7], v16, s[4:7], s46 offen offset:1024
v_add_f32 v14, v14, v42
v_fmac_f32 v15, v42, v42
v_add_f32 v12, v12, v41
v_mfma_f32_32x32x16_bf16 v[112:127], v[188:191], v[132:135], v[112:127]
ds_read_b64_tr_b16 v[148:149], v5 offset:4096
ds_read_b64_tr_b16 v[150:151], v7 offset:4096
v_fmac_f32 v13, v41, v41
v_add_f32 v14, v14, v43
v_fmac_f32 v15, v43, v43
s_waitcnt vmcnt(10) lgkmcnt(4)
v_mfma_f32_32x32x16_bf16 v[64:79], v[192:195], v[136:139], v[64:79]
ds_read_b64_tr_b16 v[200:201], v56 offset:4096
ds_read_b64_tr_b16 v[202:203], v58 offset:4096
v_lshlrev_b32 v40, 16, v136
v_and_b32 v41, v38, v136
v_lshlrev_b32 v42, 16, v140
v_mfma_f32_32x32x16_bf16 v[80:95], v[192:195], v[140:143], v[80:95]
ds_read_b64_tr_b16 v[204:205], v57 offset:4096
ds_read_b64_tr_b16 v[206:207], v59 offset:4096
buffer_load_dwordx4 a[8:11], v16, s[4:7], s46 offen offset:2048
v_and_b32 v43, v38, v140
v_add_f32 v12, v12, v40
v_fmac_f32 v13, v40, v40
v_mfma_f32_32x32x16_bf16 v[96:111], v[196:199], v[136:139], v[96:111]
ds_read_b64_tr_b16 v[152:153], v4 offset:6144
ds_read_b64_tr_b16 v[154:155], v6 offset:6144
buffer_load_dwordx4 a[12:15], v16, s[4:7], s46 offen offset:3072
v_add_f32 v14, v14, v42
v_fmac_f32 v15, v42, v42
v_add_f32 v12, v12, v41
v_mfma_f32_32x32x16_bf16 v[112:127], v[196:199], v[140:143], v[112:127]
ds_read_b64_tr_b16 v[156:157], v5 offset:6144
ds_read_b64_tr_b16 v[158:159], v7 offset:6144
v_fmac_f32 v13, v41, v41
v_add_f32 v14, v14, v43
v_fmac_f32 v15, v43, v43
s_waitcnt vmcnt(10) lgkmcnt(4)
v_mfma_f32_32x32x16_bf16 v[64:79], v[200:203], v[144:147], v[64:79]
ds_read_b64_tr_b16 v[208:209], v56 offset:6144
ds_read_b64_tr_b16 v[210:211], v58 offset:6144
v_lshlrev_b32 v40, 16, v144
v_and_b32 v41, v38, v144
v_lshlrev_b32 v42, 16, v148
v_mfma_f32_32x32x16_bf16 v[80:95], v[200:203], v[148:151], v[80:95]
ds_read_b64_tr_b16 v[212:213], v57 offset:6144
ds_read_b64_tr_b16 v[214:215], v59 offset:6144
buffer_load_dwordx4 a[16:19], v17, s[4:7], s46 offen offset:0
v_and_b32 v43, v38, v148
v_add_f32 v12, v12, v40
v_fmac_f32 v13, v40, v40
v_mfma_f32_32x32x16_bf16 v[96:111], v[204:207], v[144:147], v[96:111]
ds_read_b64_tr_b16 v[160:161], v4 offset:8192
ds_read_b64_tr_b16 v[162:163], v6 offset:8192
buffer_load_dwordx4 a[20:23], v17, s[4:7], s46 offen offset:1024
v_add_f32 v14, v14, v42
v_fmac_f32 v15, v42, v42
v_add_f32 v12, v12, v41
v_mfma_f32_32x32x16_bf16 v[112:127], v[204:207], v[148:151], v[112:127]
ds_read_b64_tr_b16 v[164:165], v5 offset:8192
ds_read_b64_tr_b16 v[166:167], v7 offset:8192
v_fmac_f32 v13, v41, v41
v_add_f32 v14, v14, v43
v_fmac_f32 v15, v43, v43
s_waitcnt vmcnt(10) lgkmcnt(4)
v_mfma_f32_32x32x16_bf16 v[64:79], v[208:211], v[152:155], v[64:79]
ds_read_b64_tr_b16 v[216:217], v56 offset:8192
ds_read_b64_tr_b16 v[218:219], v58 offset:8192
v_lshlrev_b32 v40, 16, v152
v_and_b32 v41, v38, v152
v_lshlrev_b32 v42, 16, v156
v_mfma_f32_32x32x16_bf16 v[80:95], v[208:211], v[156:159], v[80:95]
ds_read_b64_tr_b16 v[220:221], v57 offset:8192
ds_read_b64_tr_b16 v[222:223], v59 offset:8192
buffer_load_dwordx4 a[24:27], v17, s[4:7], s46 offen offset:2048
v_and_b32 v43, v38, v156
v_add_f32 v12, v12, v40
v_fmac_f32 v13, v40, v40
v_mfma_f32_32x32x16_bf16 v[96:111], v[212:215], v[152:155], v[96:111]
ds_read_b64_tr_b16 v[168:169], v4 offset:10240
ds_read_b64_tr_b16 v[170:171], v6 offset:10240
buffer_load_dwordx4 a[28:31], v17, s[4:7], s46 offen offset:3072
v_add_f32 v14, v14, v42
v_fmac_f32 v15, v42, v42
v_add_f32 v12, v12, v41
v_mfma_f32_32x32x16_bf16 v[112:127], v[212:215], v[156:159], v[112:127]
ds_read_b64_tr_b16 v[172:173], v5 offset:10240
ds_read_b64_tr_b16 v[174:175], v7 offset:10240
v_fmac_f32 v13, v41, v41
v_add_f32 v14, v14, v43
v_fmac_f32 v15, v43, v43
s_waitcnt vmcnt(10) lgkmcnt(4)
v_mfma_f32_32x32x16_bf16 v[64:79], v[216:219], v[160:163], v[64:79]
ds_read_b64_tr_b16 v[224:225], v56 offset:10240
ds_read_b64_tr_b16 v[226:227], v58 offset:10240
v_lshlrev_b32 v40, 16, v160
v_and_b32 v41, v38, v160
v_lshlrev_b32 v42, 16, v164
v_mfma_f32_32x32x16_bf16 v[80:95], v[216:219], v[164:167], v[80:95]
ds_read_b64_tr_b16 v[228:229], v57 offset:10240
ds_read_b64_tr_b16 v[230:231], v59 offset:10240
buffer_load_dwordx4 a[32:35], v18, s[4:7], s46 offen offset:0
v_and_b32 v43, v38, v164
v_add_f32 v12, v12, v40
v_fmac_f32 v13, v40, v40
v_mfma_f32_32x32x16_bf16 v[96:111], v[220:223], v[160:163], v[96:111]
ds_read_b64_tr_b16 v[176:177], v4 offset:12288
ds_read_b64_tr_b16 v[178:179], v6 offset:12288
buffer_load_dwordx4 a[36:39], v18, s[4:7], s46 offen offset:1024
v_add_f32 v14, v14, v42
v_fmac_f32 v15, v42, v42
v_add_f32 v12, v12, v41
v_mfma_f32_32x32x16_bf16 v[112:127], v[220:223], v[164:167], v[112:127]
ds_read_b64_tr_b16 v[180:181], v5 offset:12288
ds_read_b64_tr_b16 v[182:183], v7 offset:12288
v_fmac_f32 v13, v41, v41
v_add_f32 v14, v14, v43
v_fmac_f32 v15, v43, v43
s_waitcnt vmcnt(10) lgkmcnt(4)
v_mfma_f32_32x32x16_bf16 v[64:79], v[224:227], v[168:171], v[64:79]
ds_read_b64_tr_b16 v[232:233], v56 offset:12288
ds_read_b64_tr_b16 v[234:235], v58 offset:12288
v_lshlrev_b32 v40, 16, v168
v_and_b32 v41, v38, v168
v_lshlrev_b32 v42, 16, v172
v_mfma_f32_32x32x16_bf16 v[80:95], v[224:227], v[172:175], v[80:95]
ds_read_b64_tr_b16 v[236:237], v57 offset:12288
ds_read_b64_tr_b16 v[238:239], v59 offset:12288
buffer_load_dwordx4 a[40:43], v18, s[4:7], s46 offen offset:2048
v_and_b32 v43, v38, v172
v_add_f32 v12, v12, v40
v_fmac_f32 v13, v40, v40
v_mfma_f32_32x32x16_bf16 v[96:111], v[228:231], v[168:171], v[96:111]
buffer_load_dwordx4 a[44:47], v18, s[4:7], s46 offen offset:3072
v_add_f32 v14, v14, v42
v_fmac_f32 v15, v42, v42
v_add_f32 v12, v12, v41
v_mfma_f32_32x32x16_bf16 v[112:127], v[228:231], v[172:175], v[112:127]
v_fmac_f32 v13, v41, v41
v_add_f32 v14, v14, v43
v_fmac_f32 v15, v43, v43
s_waitcnt vmcnt(12) lgkmcnt(0)
v_mfma_f32_32x32x16_bf16 v[64:79], v[232:235], v[176:179], v[64:79]
v_lshlrev_b32 v40, 16, v176
v_and_b32 v41, v38, v176
v_lshlrev_b32 v42, 16, v180
v_mfma_f32_32x32x16_bf16 v[80:95], v[232:235], v[180:183], v[80:95]
buffer_load_dwordx4 a[48:51], v19, s[4:7], s46 offen offset:0
v_and_b32 v43, v38, v180
v_add_f32 v12, v12, v40
v_fmac_f32 v13, v40, v40
v_mfma_f32_32x32x16_bf16 v[96:111], v[236:239], v[176:179], v[96:111]
buffer_load_dwordx4 a[52:55], v19, s[4:7], s46 offen offset:1024
v_add_f32 v14, v14, v42
v_fmac_f32 v15, v42, v42
v_add_f32 v12, v12, v41
v_mfma_f32_32x32x16_bf16 v[112:127], v[236:239], v[180:183], v[112:127]
v_fmac_f32 v13, v41, v41
v_add_f32 v14, v14, v43
v_fmac_f32 v15, v43, v43
s_mov_b64 exec, 0x7f
buffer_load_dword v29, v27, s[52:55], s77 offen sc1
s_mov_b64 exec, -1
s_add_u32 s46, s46, 14336
buffer_load_dwordx4 a[56:59], v16, s[4:7], s46 offen offset:0
buffer_load_dwordx4 a[60:63], v16, s[4:7], s46 offen offset:1024
buffer_load_dwordx4 a[64:67], v16, s[4:7], s46 offen offset:2048
buffer_load_dwordx4 a[68:71], v16, s[4:7], s46 offen offset:3072
buffer_load_dwordx4 a[72:75], v17, s[4:7], s46 offen offset:0
buffer_load_dwordx4 a[76:79], v17, s[4:7], s46 offen offset:1024
buffer_load_dwordx4 a[80:83], v17, s[4:7], s46 offen offset:2048

s_lshl_b32 s48, s20, 10
v_add_u32 v23, s48, v16
v_add_u32 v23, 118784, v23
ds_write_b128 v23, v[12:15]
v_and_b32 v24, 31, v1
v_lshlrev_b32 v24, 4, v24
v_add_u32 v24, 118784, v24
s_waitcnt lgkmcnt(0)
s_barrier

ds_read_b128 v[128:131], v24 offset:0
ds_read_b128 v[132:135], v24 offset:512
ds_read_b128 v[136:139], v24 offset:1024
ds_read_b128 v[140:143], v24 offset:1536
ds_read_b128 v[144:147], v24 offset:2048
ds_read_b128 v[148:151], v24 offset:2560
ds_read_b128 v[152:155], v24 offset:3072
ds_read_b128 v[156:159], v24 offset:3584
buffer_load_dwordx4 a[84:87], v17, s[4:7], s46 offen offset:3072
buffer_load_dwordx4 a[88:91], v18, s[4:7], s46 offen offset:0
buffer_load_dwordx4 a[92:95], v18, s[4:7], s46 offen offset:1024
buffer_load_dwordx4 a[96:99], v18, s[4:7], s46 offen offset:2048
buffer_load_dwordx4 a[100:103], v18, s[4:7], s46 offen offset:3072
buffer_load_dwordx4 a[104:107], v19, s[4:7], s46 offen offset:0
buffer_load_dwordx4 a[108:111], v19, s[4:7], s46 offen offset:1024
s_mov_b32 s56, 0x07060706
s_mov_b32 s57, 0x05040100
v_perm_b32 v240, v248, v248, s56
v_and_b32 v40, v38, v248
v_sub_f32 v40, v248, v40
v_cvt_pk_bf16_f32 v40, v40, v40
v_perm_b32 v241, v242, v40, s57
v_mov_b32 v243, 0
v_perm_b32 v244, v249, v249, s56
v_and_b32 v40, v38, v249
v_sub_f32 v40, v249, v40
v_cvt_pk_bf16_f32 v40, v40, v40
v_perm_b32 v245, v246, v40, s57
v_mov_b32 v247, 0
s_mov_b32 exec_lo, 0
v_mov_b32 v240, 0
v_mov_b32 v241, 0
v_mov_b32 v242, 0
v_mov_b32 v244, 0
v_mov_b32 v245, 0
v_mov_b32 v246, 0
s_mov_b32 exec_lo, -1
s_mov_b32 s51, 0x3b124925
s_mov_b32 s56, 0x3727c5ac
s_mov_b32 s57, 0xc0135761
s_mov_b32 s58, 0xbdd2d3e8
v_mov_b32 v32, s57
v_mov_b32 v33, s57
v_mov_b32 v34, s58
v_mov_b32 v35, s58
v_mov_b32 v36, 1.0
v_mov_b32 v37, 1.0
s_lshr_b32 s59, s14, 2
s_and_b32 s60, s14, 3
s_mul_i32 s10, s14, 229376
s_add_u32 s10, s10, 8388608
s_add_u32 s11, s10, 114688
s_cmp_lt_u32 s59, 7
s_cselect_b32 s61, 1, 0
s_cmp_lt_u32 s60, 2
s_cselect_b32 s61, s61, 0
s_lshl_b32 s59, s59, 18
s_mul_i32 s60, s60, 114688
s_add_u32 s59, s59, s60
s_add_u32 s60, s59, 2097152
s_cmp_lg_u32 s61, 0
s_cselect_b32 s10, s59, s10
s_cselect_b32 s11, s60, s11
s_lshl_b32 s60, s45, 12
s_add_u32 s59, s10, s60
s_add_u32 s60, s11, s60
s_mul_i32 s61, s14, 56
s_add_u32 s62, s61, s45
s_lshl_b32 s62, s62, 6
s_add_u32 s63, s62, 1792
s_mul_i32 s64, s20, 7
s_add_u32 s64, s64, s61
s_lshl_b32 s64, s64, 6
s_lshl_b32 s8, s14, 8
s_add_u32 s8, s8, 114688
s_lshl_b32 s9, s45, 2
s_add_u32 s9, s9, s8
s_mul_i32 s16, s20, 28
s_add_u32 s8, s8, s16
s_waitcnt lgkmcnt(0)

v_pk_add_f32 v[128:129], v[128:129], v[132:133]
v_pk_add_f32 v[130:131], v[130:131], v[134:135]
v_pk_add_f32 v[128:129], v[128:129], v[136:137]
v_pk_add_f32 v[130:131], v[130:131], v[138:139]
v_pk_add_f32 v[128:129], v[128:129], v[140:141]
v_pk_add_f32 v[130:131], v[130:131], v[142:143]
v_pk_add_f32 v[128:129], v[128:129], v[144:145]
v_pk_add_f32 v[130:131], v[130:131], v[146:147]
v_pk_add_f32 v[128:129], v[128:129], v[148:149]
v_pk_add_f32 v[130:131], v[130:131], v[150:151]
v_pk_add_f32 v[128:129], v[128:129], v[152:153]
v_pk_add_f32 v[130:131], v[130:131], v[154:155]
v_pk_add_f32 v[128:129], v[128:129], v[156:157]
v_pk_add_f32 v[130:131], v[130:131], v[158:159]

v_mul_f32 v26, s51, v128
v_mul_f32 v27, s51, v129
v_fma_f32 v27, -v26, v26, v27
v_max_f32 v27, 0, v27
v_add_f32 v27, s56, v27
v_rsq_f32 v48, v27
v_sub_f32 v26, 0, v26
v_mul_f32 v27, v27, v48
v_mov_b32 v49, v48
v_and_b32 v40, v38, v26
v_sub_f32 v41, v26, v40
v_and_b32 v42, v38, v27
v_sub_f32 v43, v27, v42
v_cvt_pk_bf16_f32 v132, v40, v41
v_cvt_pk_bf16_f32 v133, v40, v42
v_mov_b32 v44, 0
v_cvt_pk_bf16_f32 v134, v43, v44
v_mov_b32 v135, 0

v_mul_f32 v26, s51, v130
v_mul_f32 v27, s51, v131
v_fma_f32 v27, -v26, v26, v27
v_max_f32 v27, 0, v27
v_add_f32 v27, s56, v27
v_rsq_f32 v50, v27
v_sub_f32 v26, 0, v26
v_mul_f32 v27, v27, v50
v_mov_b32 v51, v50
v_and_b32 v40, v38, v26
v_sub_f32 v41, v26, v40
v_and_b32 v42, v38, v27
v_sub_f32 v43, v27, v42
v_cvt_pk_bf16_f32 v136, v40, v41
v_cvt_pk_bf16_f32 v137, v40, v42
v_mov_b32 v44, 0
v_cvt_pk_bf16_f32 v138, v43, v44
v_mov_b32 v139, 0

s_nop 1
v_mfma_f32_32x32x16_bf16 v[64:79], v[240:243], v[132:135], v[64:79]
v_mfma_f32_32x32x16_bf16 v[80:95], v[240:243], v[136:139], v[80:95]
v_mfma_f32_32x32x16_bf16 v[96:111], v[244:247], v[132:135], v[96:111]
v_mfma_f32_32x32x16_bf16 v[112:127], v[244:247], v[136:139], v[112:127]
s_waitcnt vmcnt(14)
v_mov_b32 v39, v29
v_lshlrev_b32 v27, 2, v1
v_add_u32 v27, s8, v27
v_subrev_u32 v29, 8, v1
v_lshlrev_b32 v29, 6, v29
v_add_u32 v29, s64, v29
v_cmp_gt_u32 vcc, 8, v1
v_mov_b32 v31, 1
v_mov_b32 v24, 128
v_mov_b32 v23, 1792
v_mov_b32 v30, s76
v_cndmask_b32 v27, v29, v27, vcc
v_cndmask_b32 v31, v31, v30, vcc
v_cndmask_b32 v24, v23, v24, vcc
v_add_u32 v24, v27, v24
s_mov_b64 exec, 0x7f
v_cmp_ne_u32 vcc, s76, v39
s_mov_b64 exec, -1
s_cmp_eq_u64 vcc, 0
s_cselect_b64 vcc, -1, 0
s_cselect_b32 s79, 1, 0
s_nop 4
v_pk_mul_f32 v[164:165], v[48:49], v[64:65]
v_pk_mul_f32 v[166:167], v[48:49], v[66:67]
v_pk_mul_f32 v[168:169], v[48:49], v[68:69]
v_pk_mul_f32 v[170:171], v[48:49], v[70:71]
s_add_u32 s46, s46, 14336
buffer_load_dwordx4 a[112:115], v16, s[4:7], s46 offen offset:0
v_pk_mul_f32 v[172:173], v[164:165], v[164:165]
v_pk_mul_f32 v[174:175], v[166:167], v[166:167]
v_pk_mul_f32 v[176:177], v[168:169], v[168:169]
v_pk_mul_f32 v[178:179], v[170:171], v[170:171]
v_pk_fma_f32 v[172:173], v[172:173], v[34:35], v[32:33]
v_pk_fma_f32 v[174:175], v[174:175], v[34:35], v[32:33]
v_pk_fma_f32 v[176:177], v[176:177], v[34:35], v[32:33]
v_pk_fma_f32 v[178:179], v[178:179], v[34:35], v[32:33]
v_pk_mul_f32 v[172:173], v[172:173], v[164:165]
v_pk_mul_f32 v[174:175], v[174:175], v[166:167]
v_pk_mul_f32 v[176:177], v[176:177], v[168:169]
v_pk_mul_f32 v[178:179], v[178:179], v[170:171]
buffer_load_dwordx4 a[116:119], v16, s[4:7], s46 offen offset:1024
v_exp_f32 v172, v172
v_exp_f32 v173, v173
v_exp_f32 v174, v174
v_exp_f32 v175, v175
v_exp_f32 v176, v176
v_exp_f32 v177, v177
v_exp_f32 v178, v178
v_exp_f32 v179, v179
buffer_load_dwordx4 a[120:123], v16, s[4:7], s46 offen offset:2048
v_pk_add_f32 v[172:173], v[172:173], v[36:37]
v_pk_add_f32 v[174:175], v[174:175], v[36:37]
v_pk_add_f32 v[176:177], v[176:177], v[36:37]
v_pk_add_f32 v[178:179], v[178:179], v[36:37]
v_rcp_f32 v172, v172
v_rcp_f32 v173, v173
v_rcp_f32 v174, v174
v_rcp_f32 v175, v175
v_rcp_f32 v176, v176
v_rcp_f32 v177, v177
v_rcp_f32 v178, v178
v_rcp_f32 v179, v179
buffer_load_dwordx4 a[124:127], v16, s[4:7], s46 offen offset:3072
v_pk_mul_f32 v[172:173], v[172:173], v[164:165]
v_pk_mul_f32 v[174:175], v[174:175], v[166:167]
v_pk_mul_f32 v[176:177], v[176:177], v[168:169]
v_pk_mul_f32 v[178:179], v[178:179], v[170:171]
v_cvt_pk_bf16_f32 v180, v172, v173
v_cvt_pk_bf16_f32 v181, v174, v175
v_cvt_pk_bf16_f32 v182, v176, v177
v_cvt_pk_bf16_f32 v183, v178, v179
s_cbranch_vccz sl_1
buffer_store_dwordx4 v[180:183], v16, s[36:39], s59 offen offset:0
s_branch sd_2
sl_1:
buffer_store_dwordx4 v[180:183], v16, s[36:39], s59 offen offset:0 sc1
sd_2:
v_pk_mul_f32 v[164:165], v[48:49], v[72:73]
v_pk_mul_f32 v[166:167], v[48:49], v[74:75]
v_pk_mul_f32 v[168:169], v[48:49], v[76:77]
v_pk_mul_f32 v[170:171], v[48:49], v[78:79]
buffer_load_dwordx4 a[128:131], v17, s[4:7], s46 offen offset:0
v_pk_mul_f32 v[172:173], v[164:165], v[164:165]
v_pk_mul_f32 v[174:175], v[166:167], v[166:167]
v_pk_mul_f32 v[176:177], v[168:169], v[168:169]
v_pk_mul_f32 v[178:179], v[170:171], v[170:171]
v_pk_fma_f32 v[172:173], v[172:173], v[34:35], v[32:33]
v_pk_fma_f32 v[174:175], v[174:175], v[34:35], v[32:33]
v_pk_fma_f32 v[176:177], v[176:177], v[34:35], v[32:33]
v_pk_fma_f32 v[178:179], v[178:179], v[34:35], v[32:33]
v_pk_mul_f32 v[172:173], v[172:173], v[164:165]
v_pk_mul_f32 v[174:175], v[174:175], v[166:167]
v_pk_mul_f32 v[176:177], v[176:177], v[168:169]
v_pk_mul_f32 v[178:179], v[178:179], v[170:171]
buffer_load_dwordx4 a[132:135], v17, s[4:7], s46 offen offset:1024
v_exp_f32 v172, v172
v_exp_f32 v173, v173
v_exp_f32 v174, v174
v_exp_f32 v175, v175
v_exp_f32 v176, v176
v_exp_f32 v177, v177
v_exp_f32 v178, v178
v_exp_f32 v179, v179
buffer_load_dwordx4 a[136:139], v17, s[4:7], s46 offen offset:2048
v_pk_add_f32 v[172:173], v[172:173], v[36:37]
v_pk_add_f32 v[174:175], v[174:175], v[36:37]
v_pk_add_f32 v[176:177], v[176:177], v[36:37]
v_pk_add_f32 v[178:179], v[178:179], v[36:37]
v_rcp_f32 v172, v172
v_rcp_f32 v173, v173
v_rcp_f32 v174, v174
v_rcp_f32 v175, v175
v_rcp_f32 v176, v176
v_rcp_f32 v177, v177
v_rcp_f32 v178, v178
v_rcp_f32 v179, v179
buffer_load_dwordx4 a[140:143], v17, s[4:7], s46 offen offset:3072
v_pk_mul_f32 v[172:173], v[172:173], v[164:165]
v_pk_mul_f32 v[174:175], v[174:175], v[166:167]
v_pk_mul_f32 v[176:177], v[176:177], v[168:169]
v_pk_mul_f32 v[178:179], v[178:179], v[170:171]
v_cvt_pk_bf16_f32 v232, v172, v173
v_cvt_pk_bf16_f32 v233, v174, v175
v_cvt_pk_bf16_f32 v234, v176, v177
v_cvt_pk_bf16_f32 v235, v178, v179
s_cbranch_vccz sl_3
buffer_store_dwordx4 v[232:235], v16, s[36:39], s59 offen offset:1024
s_branch sd_4
sl_3:
buffer_store_dwordx4 v[232:235], v16, s[36:39], s59 offen offset:1024 sc1
sd_4:
v_pk_mul_f32 v[164:165], v[48:49], v[96:97]
v_pk_mul_f32 v[166:167], v[48:49], v[98:99]
v_pk_mul_f32 v[168:169], v[48:49], v[100:101]
v_pk_mul_f32 v[170:171], v[48:49], v[102:103]
buffer_load_dwordx4 a[144:147], v18, s[4:7], s46 offen offset:0
v_pk_mul_f32 v[172:173], v[164:165], v[164:165]
v_pk_mul_f32 v[174:175], v[166:167], v[166:167]
v_pk_mul_f32 v[176:177], v[168:169], v[168:169]
v_pk_mul_f32 v[178:179], v[170:171], v[170:171]
v_pk_fma_f32 v[172:173], v[172:173], v[34:35], v[32:33]
v_pk_fma_f32 v[174:175], v[174:175], v[34:35], v[32:33]
v_pk_fma_f32 v[176:177], v[176:177], v[34:35], v[32:33]
v_pk_fma_f32 v[178:179], v[178:179], v[34:35], v[32:33]
v_pk_mul_f32 v[172:173], v[172:173], v[164:165]
v_pk_mul_f32 v[174:175], v[174:175], v[166:167]
v_pk_mul_f32 v[176:177], v[176:177], v[168:169]
v_pk_mul_f32 v[178:179], v[178:179], v[170:171]
buffer_load_dwordx4 a[148:151], v18, s[4:7], s46 offen offset:1024
v_exp_f32 v172, v172
v_exp_f32 v173, v173
v_exp_f32 v174, v174
v_exp_f32 v175, v175
v_exp_f32 v176, v176
v_exp_f32 v177, v177
v_exp_f32 v178, v178
v_exp_f32 v179, v179
buffer_load_dwordx4 a[152:155], v18, s[4:7], s46 offen offset:2048
v_pk_add_f32 v[172:173], v[172:173], v[36:37]
v_pk_add_f32 v[174:175], v[174:175], v[36:37]
v_pk_add_f32 v[176:177], v[176:177], v[36:37]
v_pk_add_f32 v[178:179], v[178:179], v[36:37]
v_rcp_f32 v172, v172
v_rcp_f32 v173, v173
v_rcp_f32 v174, v174
v_rcp_f32 v175, v175
v_rcp_f32 v176, v176
v_rcp_f32 v177, v177
v_rcp_f32 v178, v178
v_rcp_f32 v179, v179
buffer_load_dwordx4 a[156:159], v18, s[4:7], s46 offen offset:3072
v_pk_mul_f32 v[172:173], v[172:173], v[164:165]
v_pk_mul_f32 v[174:175], v[174:175], v[166:167]
v_pk_mul_f32 v[176:177], v[176:177], v[168:169]
v_pk_mul_f32 v[178:179], v[178:179], v[170:171]
v_cvt_pk_bf16_f32 v180, v172, v173
v_cvt_pk_bf16_f32 v181, v174, v175
v_cvt_pk_bf16_f32 v182, v176, v177
v_cvt_pk_bf16_f32 v183, v178, v179
s_cbranch_vccz sl_5
buffer_store_dwordx4 v[180:183], v16, s[36:39], s59 offen offset:2048
s_branch sd_6
sl_5:
buffer_store_dwordx4 v[180:183], v16, s[36:39], s59 offen offset:2048 sc1
sd_6:
v_pk_mul_f32 v[164:165], v[48:49], v[104:105]
v_pk_mul_f32 v[166:167], v[48:49], v[106:107]
v_pk_mul_f32 v[168:169], v[48:49], v[108:109]
v_pk_mul_f32 v[170:171], v[48:49], v[110:111]
v_pk_mul_f32 v[172:173], v[164:165], v[164:165]
v_pk_mul_f32 v[174:175], v[166:167], v[166:167]
v_pk_mul_f32 v[176:177], v[168:169], v[168:169]
v_pk_mul_f32 v[178:179], v[170:171], v[170:171]
buffer_load_dwordx4 a[160:163], v19, s[4:7], s46 offen offset:0
v_pk_fma_f32 v[172:173], v[172:173], v[34:35], v[32:33]
v_pk_fma_f32 v[174:175], v[174:175], v[34:35], v[32:33]
v_pk_fma_f32 v[176:177], v[176:177], v[34:35], v[32:33]
v_pk_fma_f32 v[178:179], v[178:179], v[34:35], v[32:33]
v_pk_mul_f32 v[172:173], v[172:173], v[164:165]
v_pk_mul_f32 v[174:175], v[174:175], v[166:167]
v_pk_mul_f32 v[176:177], v[176:177], v[168:169]
v_pk_mul_f32 v[178:179], v[178:179], v[170:171]
v_exp_f32 v172, v172
v_exp_f32 v173, v173
v_exp_f32 v174, v174
v_exp_f32 v175, v175
v_exp_f32 v176, v176
v_exp_f32 v177, v177
v_exp_f32 v178, v178
v_exp_f32 v179, v179
buffer_load_dwordx4 a[164:167], v19, s[4:7], s46 offen offset:1024
v_pk_add_f32 v[172:173], v[172:173], v[36:37]
v_pk_add_f32 v[174:175], v[174:175], v[36:37]
v_pk_add_f32 v[176:177], v[176:177], v[36:37]
v_pk_add_f32 v[178:179], v[178:179], v[36:37]
v_rcp_f32 v172, v172
v_rcp_f32 v173, v173
v_rcp_f32 v174, v174
v_rcp_f32 v175, v175
v_rcp_f32 v176, v176
v_rcp_f32 v177, v177
v_rcp_f32 v178, v178
v_rcp_f32 v179, v179
s_add_u32 s46, s46, 14336
buffer_load_dwordx4 a[168:171], v16, s[4:7], s46 offen offset:0
v_pk_mul_f32 v[172:173], v[172:173], v[164:165]
v_pk_mul_f32 v[174:175], v[174:175], v[166:167]
v_pk_mul_f32 v[176:177], v[176:177], v[168:169]
v_pk_mul_f32 v[178:179], v[178:179], v[170:171]
v_cvt_pk_bf16_f32 v232, v172, v173
v_cvt_pk_bf16_f32 v233, v174, v175
v_cvt_pk_bf16_f32 v234, v176, v177
v_cvt_pk_bf16_f32 v235, v178, v179
s_cbranch_vccz sl_7
buffer_store_dwordx4 v[232:235], v16, s[36:39], s59 offen offset:3072
s_branch sd_8
sl_7:
buffer_store_dwordx4 v[232:235], v16, s[36:39], s59 offen offset:3072 sc1
sd_8:
v_pk_mul_f32 v[164:165], v[50:51], v[80:81]
v_pk_mul_f32 v[166:167], v[50:51], v[82:83]
v_pk_mul_f32 v[168:169], v[50:51], v[84:85]
v_pk_mul_f32 v[170:171], v[50:51], v[86:87]
buffer_load_dwordx4 a[172:175], v16, s[4:7], s46 offen offset:1024
v_pk_mul_f32 v[172:173], v[164:165], v[164:165]
v_pk_mul_f32 v[174:175], v[166:167], v[166:167]
v_pk_mul_f32 v[176:177], v[168:169], v[168:169]
v_pk_mul_f32 v[178:179], v[170:171], v[170:171]
v_pk_fma_f32 v[172:173], v[172:173], v[34:35], v[32:33]
v_pk_fma_f32 v[174:175], v[174:175], v[34:35], v[32:33]
v_pk_fma_f32 v[176:177], v[176:177], v[34:35], v[32:33]
v_pk_fma_f32 v[178:179], v[178:179], v[34:35], v[32:33]
v_pk_mul_f32 v[172:173], v[172:173], v[164:165]
v_pk_mul_f32 v[174:175], v[174:175], v[166:167]
v_pk_mul_f32 v[176:177], v[176:177], v[168:169]
v_pk_mul_f32 v[178:179], v[178:179], v[170:171]
buffer_load_dwordx4 a[176:179], v16, s[4:7], s46 offen offset:2048
v_exp_f32 v172, v172
v_exp_f32 v173, v173
v_exp_f32 v174, v174
v_exp_f32 v175, v175
v_exp_f32 v176, v176
v_exp_f32 v177, v177
v_exp_f32 v178, v178
v_exp_f32 v179, v179
buffer_load_dwordx4 a[180:183], v16, s[4:7], s46 offen offset:3072
v_pk_add_f32 v[172:173], v[172:173], v[36:37]
v_pk_add_f32 v[174:175], v[174:175], v[36:37]
v_pk_add_f32 v[176:177], v[176:177], v[36:37]
v_pk_add_f32 v[178:179], v[178:179], v[36:37]
v_rcp_f32 v172, v172
v_rcp_f32 v173, v173
v_rcp_f32 v174, v174
v_rcp_f32 v175, v175
v_rcp_f32 v176, v176
v_rcp_f32 v177, v177
v_rcp_f32 v178, v178
v_rcp_f32 v179, v179
buffer_load_dwordx4 a[184:187], v17, s[4:7], s46 offen offset:0
v_pk_mul_f32 v[172:173], v[172:173], v[164:165]
v_pk_mul_f32 v[174:175], v[174:175], v[166:167]
v_pk_mul_f32 v[176:177], v[176:177], v[168:169]
v_pk_mul_f32 v[178:179], v[178:179], v[170:171]
v_cvt_pk_bf16_f32 v180, v172, v173
v_cvt_pk_bf16_f32 v181, v174, v175
v_cvt_pk_bf16_f32 v182, v176, v177
v_cvt_pk_bf16_f32 v183, v178, v179
s_cbranch_vccz sl_9
buffer_store_dwordx4 v[180:183], v16, s[36:39], s60 offen offset:0
s_branch sd_10
sl_9:
buffer_store_dwordx4 v[180:183], v16, s[36:39], s60 offen offset:0 sc1
sd_10:
v_pk_mul_f32 v[164:165], v[50:51], v[88:89]
v_pk_mul_f32 v[166:167], v[50:51], v[90:91]
v_pk_mul_f32 v[168:169], v[50:51], v[92:93]
v_pk_mul_f32 v[170:171], v[50:51], v[94:95]
v_pk_mul_f32 v[172:173], v[164:165], v[164:165]
v_pk_mul_f32 v[174:175], v[166:167], v[166:167]
v_pk_mul_f32 v[176:177], v[168:169], v[168:169]
v_pk_mul_f32 v[178:179], v[170:171], v[170:171]
buffer_load_dwordx4 a[188:191], v17, s[4:7], s46 offen offset:1024
v_pk_fma_f32 v[172:173], v[172:173], v[34:35], v[32:33]
v_pk_fma_f32 v[174:175], v[174:175], v[34:35], v[32:33]
v_pk_fma_f32 v[176:177], v[176:177], v[34:35], v[32:33]
v_pk_fma_f32 v[178:179], v[178:179], v[34:35], v[32:33]
v_pk_mul_f32 v[172:173], v[172:173], v[164:165]
v_pk_mul_f32 v[174:175], v[174:175], v[166:167]
v_pk_mul_f32 v[176:177], v[176:177], v[168:169]
v_pk_mul_f32 v[178:179], v[178:179], v[170:171]
v_exp_f32 v172, v172
v_exp_f32 v173, v173
v_exp_f32 v174, v174
v_exp_f32 v175, v175
v_exp_f32 v176, v176
v_exp_f32 v177, v177
v_exp_f32 v178, v178
v_exp_f32 v179, v179
buffer_load_dwordx4 a[192:195], v17, s[4:7], s46 offen offset:2048
v_pk_add_f32 v[172:173], v[172:173], v[36:37]
v_pk_add_f32 v[174:175], v[174:175], v[36:37]
v_pk_add_f32 v[176:177], v[176:177], v[36:37]
v_pk_add_f32 v[178:179], v[178:179], v[36:37]
v_rcp_f32 v172, v172
v_rcp_f32 v173, v173
v_rcp_f32 v174, v174
v_rcp_f32 v175, v175
v_rcp_f32 v176, v176
v_rcp_f32 v177, v177
v_rcp_f32 v178, v178
v_rcp_f32 v179, v179
s_nop 0
v_pk_mul_f32 v[172:173], v[172:173], v[164:165]
v_pk_mul_f32 v[174:175], v[174:175], v[166:167]
v_pk_mul_f32 v[176:177], v[176:177], v[168:169]
v_pk_mul_f32 v[178:179], v[178:179], v[170:171]
v_cvt_pk_bf16_f32 v232, v172, v173
v_cvt_pk_bf16_f32 v233, v174, v175
v_cvt_pk_bf16_f32 v234, v176, v177
v_cvt_pk_bf16_f32 v235, v178, v179
s_cbranch_vccz sl_11
buffer_store_dwordx4 v[232:235], v16, s[36:39], s60 offen offset:1024
s_branch sd_12
sl_11:
buffer_store_dwordx4 v[232:235], v16, s[36:39], s60 offen offset:1024 sc1
sd_12:
s_waitcnt vmcnt(8)
v_mov_b32 v25, 1
v_mov_b32 v26, 0
v_mov_b32 v30, s76
s_mov_b64 exec, 1
s_cmp_eq_u32 s79, 0
s_cbranch_scc1 pg_17
buffer_store_dword v30, v26, s[52:55], s9 offen offset:0
s_branch pd_18
pg_17:
buffer_store_dword v25, v26, s[52:55], s62 offen sc1
pd_18:
s_mov_b64 exec, -1
v_pk_mul_f32 v[164:165], v[50:51], v[112:113]
v_pk_mul_f32 v[166:167], v[50:51], v[114:115]
v_pk_mul_f32 v[168:169], v[50:51], v[116:117]
v_pk_mul_f32 v[170:171], v[50:51], v[118:119]
v_pk_mul_f32 v[172:173], v[164:165], v[164:165]
v_pk_mul_f32 v[174:175], v[166:167], v[166:167]
v_pk_mul_f32 v[176:177], v[168:169], v[168:169]
v_pk_mul_f32 v[178:179], v[170:171], v[170:171]
v_pk_fma_f32 v[172:173], v[172:173], v[34:35], v[32:33]
v_pk_fma_f32 v[174:175], v[174:175], v[34:35], v[32:33]
v_pk_fma_f32 v[176:177], v[176:177], v[34:35], v[32:33]
v_pk_fma_f32 v[178:179], v[178:179], v[34:35], v[32:33]
v_pk_mul_f32 v[172:173], v[172:173], v[164:165]
v_pk_mul_f32 v[174:175], v[174:175], v[166:167]
v_pk_mul_f32 v[176:177], v[176:177], v[168:169]
v_pk_mul_f32 v[178:179], v[178:179], v[170:171]
v_exp_f32 v172, v172
v_exp_f32 v173, v173
v_exp_f32 v174, v174
v_exp_f32 v175, v175
v_exp_f32 v176, v176
v_exp_f32 v177, v177
v_exp_f32 v178, v178
v_exp_f32 v179, v179
s_nop 0
v_pk_add_f32 v[172:173], v[172:173], v[36:37]
v_pk_add_f32 v[174:175], v[174:175], v[36:37]
v_pk_add_f32 v[176:177], v[176:177], v[36:37]
v_pk_add_f32 v[178:179], v[178:179], v[36:37]
v_rcp_f32 v172, v172
v_rcp_f32 v173, v173
v_rcp_f32 v174, v174
v_rcp_f32 v175, v175
v_rcp_f32 v176, v176
v_rcp_f32 v177, v177
v_rcp_f32 v178, v178
v_rcp_f32 v179, v179
s_nop 0
v_pk_mul_f32 v[172:173], v[172:173], v[164:165]
v_pk_mul_f32 v[174:175], v[174:175], v[166:167]
v_pk_mul_f32 v[176:177], v[176:177], v[168:169]
v_pk_mul_f32 v[178:179], v[178:179], v[170:171]
v_cvt_pk_bf16_f32 v180, v172, v173
v_cvt_pk_bf16_f32 v181, v174, v175
v_cvt_pk_bf16_f32 v182, v176, v177
v_cvt_pk_bf16_f32 v183, v178, v179
s_cbranch_vccz sl_13
buffer_store_dwordx4 v[180:183], v16, s[36:39], s60 offen offset:2048
s_branch sd_14
sl_13:
buffer_store_dwordx4 v[180:183], v16, s[36:39], s60 offen offset:2048 sc1
sd_14:
v_pk_mul_f32 v[164:165], v[50:51], v[120:121]
v_pk_mul_f32 v[166:167], v[50:51], v[122:123]
v_pk_mul_f32 v[168:169], v[50:51], v[124:125]
v_pk_mul_f32 v[170:171], v[50:51], v[126:127]
v_pk_mul_f32 v[172:173], v[164:165], v[164:165]
v_pk_mul_f32 v[174:175], v[166:167], v[166:167]
v_pk_mul_f32 v[176:177], v[168:169], v[168:169]
v_pk_mul_f32 v[178:179], v[170:171], v[170:171]
v_pk_fma_f32 v[172:173], v[172:173], v[34:35], v[32:33]
v_pk_fma_f32 v[174:175], v[174:175], v[34:35], v[32:33]
v_pk_fma_f32 v[176:177], v[176:177], v[34:35], v[32:33]
v_pk_fma_f32 v[178:179], v[178:179], v[34:35], v[32:33]
v_pk_mul_f32 v[172:173], v[172:173], v[164:165]
v_pk_mul_f32 v[174:175], v[174:175], v[166:167]
v_pk_mul_f32 v[176:177], v[176:177], v[168:169]
v_pk_mul_f32 v[178:179], v[178:179], v[170:171]
v_exp_f32 v172, v172
v_exp_f32 v173, v173
v_exp_f32 v174, v174
v_exp_f32 v175, v175
v_exp_f32 v176, v176
v_exp_f32 v177, v177
v_exp_f32 v178, v178
v_exp_f32 v179, v179
s_nop 0
v_pk_add_f32 v[172:173], v[172:173], v[36:37]
v_pk_add_f32 v[174:175], v[174:175], v[36:37]
v_pk_add_f32 v[176:177], v[176:177], v[36:37]
v_pk_add_f32 v[178:179], v[178:179], v[36:37]
v_rcp_f32 v172, v172
v_rcp_f32 v173, v173
v_rcp_f32 v174, v174
v_rcp_f32 v175, v175
v_rcp_f32 v176, v176
v_rcp_f32 v177, v177
v_rcp_f32 v178, v178
v_rcp_f32 v179, v179
s_nop 0
v_pk_mul_f32 v[172:173], v[172:173], v[164:165]
v_pk_mul_f32 v[174:175], v[174:175], v[166:167]
v_pk_mul_f32 v[176:177], v[176:177], v[168:169]
v_pk_mul_f32 v[178:179], v[178:179], v[170:171]
v_cvt_pk_bf16_f32 v232, v172, v173
v_cvt_pk_bf16_f32 v233, v174, v175
v_cvt_pk_bf16_f32 v234, v176, v177
v_cvt_pk_bf16_f32 v235, v178, v179
s_cbranch_vccz sl_15
buffer_store_dwordx4 v[232:235], v16, s[36:39], s60 offen offset:3072
s_branch sd_16
sl_15:
buffer_store_dwordx4 v[232:235], v16, s[36:39], s60 offen offset:3072 sc1
sd_16:

s_mov_b64 exec, 0x7f7f
buffer_load_dword v28, v27, s[52:55], 0 offen sc1
s_mov_b64 exec, -1
s_mul_i32 s70, s20, 28*1024
s_add_u32 s69, s10, s70
s_add_u32 s70, s11, s70

buffer_load_dwordx4 a[196:199], v17, s[4:7], s46 offen offset:3072
buffer_load_dwordx4 a[200:203], v18, s[4:7], s46 offen offset:0
buffer_load_dwordx4 a[204:207], v18, s[4:7], s46 offen offset:1024
buffer_load_dwordx4 a[208:211], v18, s[4:7], s46 offen offset:2048
buffer_load_dwordx4 a[212:215], v18, s[4:7], s46 offen offset:3072
buffer_load_dwordx4 a[216:219], v19, s[4:7], s46 offen offset:0
buffer_load_dwordx4 a[220:223], v19, s[4:7], s46 offen offset:1024
s_mov_b32 s28, s72
s_mov_b32 s29, s73
s_mov_b32 s30, 896
s_mov_b32 s31, 0x20000
s_mov_b32 s40, s74
s_mov_b32 s41, s75
s_mov_b32 s42, 1835008
s_mov_b32 s43, 0x20000

s_lshr_b32 s16, s20, 1
s_and_b32 s17, s20, 1
v_lshrrev_b32 v19, 5, v1
v_lshlrev_b32 v19, 2, v19
s_lshl_b32 s19, s15, 6
s_lshl_b32 s21, s16, 5
s_add_u32 s19, s19, s21
v_add_u32 v19, s19, v19
v_lshlrev_b32 v20, 1, v19
v_add_u32 v19, 12288, v16
v_bfe_u32 v7, v1, 2, 2
v_lshrrev_b32 v6, 5, v1
v_lshl_add_u32 v6, v6, 2, v7
v_lshlrev_b32 v4, 7, v6
v_lshrrev_b32 v7, 1, v7
v_lshl_add_u32 v4, v7, 6, v4
v_bfe_u32 v7, v1, 4, 1
v_lshl_add_u32 v4, v7, 5, v4
v_and_b32 v7, 3, v1
v_lshl_add_u32 v4, v7, 3, v4
s_lshl_b32 s18, s17, 6
v_xor_b32 v4, s18, v4
s_lshl_b32 s18, s15, 13
s_lshl_b32 s22, s16, 12
s_add_u32 s18, s18, s22
v_add_u32 v4, s18, v4
v_lshrrev_b32 v22, 3, v1
s_lshl_b32 s21, s14, 6
s_lshl_b32 s22, s20, 4
s_add_u32 s21, s21, s22
v_add_u32 v21, s21, v22
s_movk_i32 s22, 896
v_mul_lo_u32 v21, v21, s22
v_and_b32 v23, 7, v1
v_lshl_add_u32 v21, v23, 4, v21
s_lshl_b32 s22, s15, 7
v_add_u32 v21, s22, v21
s_mul_i32 s18, s20, 4352
s_add_u32 s18, s18, 61440
v_add_u32 v5, s18, v16
v_lshrrev_b32 v7, 2, v23
v_mul_u32_u24 v7, 34816, v7
v_and_b32 v23, 3, v23
v_mul_u32_u24 v23, 1088, v23
v_add_u32 v7, v7, v23
v_lshl_add_u32 v7, v22, 4, v7
s_lshr_b32 s18, s20, 1
s_mul_i32 s18, s18, 17408
s_and_b32 s22, s20, 1
s_lshl_b32 s22, s22, 8
s_add_u32 s18, s18, s22
s_add_u32 s18, s18, 61440
v_add_u32 v6, s18, v7

ds_read_b64_tr_b16 v[200:201], v4 offset:0
ds_read_b64_tr_b16 v[202:203], v4 offset:1024
ds_read_b64_tr_b16 v[204:205], v4 offset:2048
ds_read_b64_tr_b16 v[206:207], v4 offset:3072
buffer_load_dwordx2 v[208:209], v20, s[28:31], 0 offen offset:0
buffer_load_dwordx2 v[210:211], v20, s[28:31], 0 offen offset:16
buffer_load_dwordx2 v[212:213], v20, s[28:31], 0 offen offset:32
buffer_load_dwordx2 v[214:215], v20, s[28:31], 0 offen offset:48
s_waitcnt vmcnt(11)
s_mov_b64 exec, 1
s_cmp_eq_u32 s79, 0
s_cbranch_scc1 pg_19
buffer_store_dword v30, v26, s[52:55], s9 offen offset:128
s_branch pd_20
pg_19:
buffer_store_dword v25, v26, s[52:55], s63 offen sc1
pd_20:
s_mov_b64 exec, -1
s_mov_b64 exec, 0x7f7f
s_mov_b32 s65, 0
v_cmp_eq_u32 vcc, v31, v28
s_lshr_b64 s[66:67], vcc, 8
s_or_b32 s66, s66, vcc_lo
s_and_b32 s66, s66, 0x7f
s_cmp_eq_u32 s66, 0x7f
s_cbranch_scc1 ffn_kernel_p0x
ffn_kernel_p0:
buffer_load_dword v28, v27, s[52:55], 0 offen sc1
s_waitcnt vmcnt(0)
v_cmp_eq_u32 vcc, v31, v28
s_lshr_b64 s[66:67], vcc, 8
s_or_b32 s66, s66, vcc_lo
s_and_b32 s66, s66, 0x7f
s_cmp_eq_u32 s66, 0x7f
s_cbranch_scc1 ffn_kernel_p0x
s_add_u32 s65, s65, 1
s_cmp_gt_u32 s65, 0x40000
s_cbranch_scc1 ffn_kernel_p0x
s_sleep 1
s_branch ffn_kernel_p0
ffn_kernel_p0x:
s_mov_b64 exec, -1

buffer_load_dwordx4 v[128:131], v16, s[36:39], s69 offen offset:0 sc1
buffer_load_dwordx4 v[132:135], v16, s[36:39], s69 offen offset:1024 sc1
buffer_load_dwordx4 v[136:139], v16, s[36:39], s69 offen offset:2048 sc1
buffer_load_dwordx4 v[140:143], v16, s[36:39], s69 offen offset:3072 sc1
buffer_load_dwordx4 v[144:147], v17, s[36:39], s69 offen offset:0 sc1
buffer_load_dwordx4 v[148:151], v17, s[36:39], s69 offen offset:1024 sc1
buffer_load_dwordx4 v[152:155], v17, s[36:39], s69 offen offset:2048 sc1
buffer_load_dwordx4 v[156:159], v17, s[36:39], s69 offen offset:3072 sc1
buffer_load_dwordx4 v[160:163], v18, s[36:39], s69 offen offset:0 sc1
buffer_load_dwordx4 v[164:167], v18, s[36:39], s69 offen offset:1024 sc1
buffer_load_dwordx4 v[168:171], v18, s[36:39], s69 offen offset:2048 sc1
buffer_load_dwordx4 v[172:175], v18, s[36:39], s69 offen offset:3072 sc1
buffer_load_dwordx4 v[176:179], v19, s[36:39], s69 offen offset:0 sc1
buffer_load_dwordx4 v[180:183], v19, s[36:39], s69 offen offset:1024 sc1
s_waitcnt vmcnt(13)
v_mfma_f32_32x32x16_bf16 v[64:79], a[0:3], v[128:131], 0
v_mfma_f32_32x32x16_bf16 v[96:111], a[4:7], v[128:131], 0
buffer_load_dwordx4 v[128:131], v19, s[36:39], s69 offen offset:2048 sc1
s_waitcnt vmcnt(13)
v_mfma_f32_32x32x16_bf16 v[64:79], a[8:11], v[132:135], v[64:79]
v_mfma_f32_32x32x16_bf16 v[96:111], a[12:15], v[132:135], v[96:111]
buffer_load_dwordx4 v[132:135], v19, s[36:39], s69 offen offset:3072 sc1
s_waitcnt vmcnt(13)
v_mfma_f32_32x32x16_bf16 v[64:79], a[16:19], v[136:139], v[64:79]
v_mfma_f32_32x32x16_bf16 v[96:111], a[20:23], v[136:139], v[96:111]
s_add_u32 s69, s69, 16384
buffer_load_dwordx4 v[136:139], v16, s[36:39], s69 offen offset:0 sc1
s_waitcnt vmcnt(13)
v_mfma_f32_32x32x16_bf16 v[64:79], a[24:27], v[140:143], v[64:79]
v_mfma_f32_32x32x16_bf16 v[96:111], a[28:31], v[140:143], v[96:111]
buffer_load_dwordx4 v[140:143], v16, s[36:39], s69 offen offset:1024 sc1
s_waitcnt vmcnt(13)
v_mfma_f32_32x32x16_bf16 v[64:79], a[32:35], v[144:147], v[64:79]
v_mfma_f32_32x32x16_bf16 v[96:111], a[36:39], v[144:147], v[96:111]
buffer_load_dwordx4 v[144:147], v16, s[36:39], s69 offen offset:2048 sc1
s_waitcnt vmcnt(13)
v_mfma_f32_32x32x16_bf16 v[64:79], a[40:43], v[148:151], v[64:79]
v_mfma_f32_32x32x16_bf16 v[96:111], a[44:47], v[148:151], v[96:111]
buffer_load_dwordx4 v[148:151], v16, s[36:39], s69 offen offset:3072 sc1
s_waitcnt vmcnt(13)
v_mfma_f32_32x32x16_bf16 v[64:79], a[48:51], v[152:155], v[64:79]
v_mfma_f32_32x32x16_bf16 v[96:111], a[52:55], v[152:155], v[96:111]
buffer_load_dwordx4 v[152:155], v17, s[36:39], s69 offen offset:0 sc1
s_mov_b64 exec, 0x7f7f
buffer_load_dword v28, v24, s[52:55], 0 offen sc1
s_mov_b64 exec, -1
s_waitcnt vmcnt(14)
v_mfma_f32_32x32x16_bf16 v[64:79], a[56:59], v[156:159], v[64:79]
v_mfma_f32_32x32x16_bf16 v[96:111], a[60:63], v[156:159], v[96:111]
buffer_load_dwordx4 v[156:159], v17, s[36:39], s69 offen offset:1024 sc1
s_waitcnt vmcnt(14)
v_mfma_f32_32x32x16_bf16 v[64:79], a[64:67], v[160:163], v[64:79]
v_mfma_f32_32x32x16_bf16 v[96:111], a[68:71], v[160:163], v[96:111]
buffer_load_dwordx4 v[160:163], v17, s[36:39], s69 offen offset:2048 sc1
s_waitcnt vmcnt(14)
v_mfma_f32_32x32x16_bf16 v[64:79], a[72:75], v[164:167], v[64:79]
v_mfma_f32_32x32x16_bf16 v[96:111], a[76:79], v[164:167], v[96:111]
buffer_load_dwordx4 v[164:167], v17, s[36:39], s69 offen offset:3072 sc1
s_waitcnt vmcnt(14)
v_mfma_f32_32x32x16_bf16 v[64:79], a[80:83], v[168:171], v[64:79]
v_mfma_f32_32x32x16_bf16 v[96:111], a[84:87], v[168:171], v[96:111]
buffer_load_dwordx4 v[168:171], v18, s[36:39], s69 offen offset:0 sc1
s_waitcnt vmcnt(14)
v_mfma_f32_32x32x16_bf16 v[64:79], a[88:91], v[172:175], v[64:79]
v_mfma_f32_32x32x16_bf16 v[96:111], a[92:95], v[172:175], v[96:111]
buffer_load_dwordx4 v[172:175], v18, s[36:39], s69 offen offset:1024 sc1
s_waitcnt vmcnt(14)
v_mfma_f32_32x32x16_bf16 v[64:79], a[96:99], v[176:179], v[64:79]
v_mfma_f32_32x32x16_bf16 v[96:111], a[100:103], v[176:179], v[96:111]
buffer_load_dwordx4 v[176:179], v18, s[36:39], s69 offen offset:2048 sc1
s_waitcnt vmcnt(14)
v_mfma_f32_32x32x16_bf16 v[64:79], a[104:107], v[180:183], v[64:79]
v_mfma_f32_32x32x16_bf16 v[96:111], a[108:111], v[180:183], v[96:111]
buffer_load_dwordx4 v[180:183], v18, s[36:39], s69 offen offset:3072 sc1
s_waitcnt vmcnt(14)
v_mfma_f32_32x32x16_bf16 v[64:79], a[112:115], v[128:131], v[64:79]
v_mfma_f32_32x32x16_bf16 v[96:111], a[116:119], v[128:131], v[96:111]
s_mov_b64 exec, 0x7f7f
s_waitcnt vmcnt(7)
v_cmp_eq_u32 vcc, v31, v28
s_lshr_b64 s[66:67], vcc, 8
s_or_b32 s66, s66, vcc_lo
s_and_b32 s66, s66, 0x7f
s_cmp_eq_u32 s66, 0x7f
s_cbranch_scc1 ok_21
s_mov_b32 s65, 0
pl_22:
buffer_load_dword v28, v24, s[52:55], 0 offen sc1
s_waitcnt vmcnt(0)
v_cmp_eq_u32 vcc, v31, v28
s_lshr_b64 s[66:67], vcc, 8
s_or_b32 s66, s66, vcc_lo
s_and_b32 s66, s66, 0x7f
s_cmp_eq_u32 s66, 0x7f
s_cbranch_scc1 ok_21
s_add_u32 s65, s65, 1
s_cmp_gt_u32 s65, 0x40000
s_cbranch_scc1 ok_21
s_sleep 1
s_branch pl_22
ok_21:
s_mov_b64 exec, -1
buffer_load_dwordx4 v[128:131], v16, s[36:39], s70 offen offset:0 sc1
s_waitcnt vmcnt(14)
v_mfma_f32_32x32x16_bf16 v[64:79], a[120:123], v[132:135], v[64:79]
v_mfma_f32_32x32x16_bf16 v[96:111], a[124:127], v[132:135], v[96:111]
buffer_load_dwordx4 v[132:135], v16, s[36:39], s70 offen offset:1024 sc1
s_waitcnt vmcnt(14)
v_mfma_f32_32x32x16_bf16 v[64:79], a[128:131], v[136:139], v[64:79]
s_waitcnt lgkmcnt(0)
v_lshlrev_b32 v22, 16, v200
v_and_b32 v23, v38, v200
v_lshlrev_b32 v216, 16, v208
v_and_b32 v217, v38, v208
v_add_f32 v216, v216, v22
v_add_f32 v217, v217, v23
v_lshlrev_b32 v22, 16, v201
v_and_b32 v23, v38, v201
v_lshlrev_b32 v218, 16, v209
v_and_b32 v219, v38, v209
v_add_f32 v218, v218, v22
v_add_f32 v219, v219, v23
v_mfma_f32_32x32x16_bf16 v[96:111], a[132:135], v[136:139], v[96:111]
v_lshlrev_b32 v22, 16, v202
v_and_b32 v23, v38, v202
v_lshlrev_b32 v220, 16, v210
v_and_b32 v221, v38, v210
v_add_f32 v220, v220, v22
v_add_f32 v221, v221, v23
v_lshlrev_b32 v22, 16, v203
v_and_b32 v23, v38, v203
v_lshlrev_b32 v222, 16, v211
v_and_b32 v223, v38, v211
v_add_f32 v222, v222, v22
v_add_f32 v223, v223, v23
v_lshlrev_b32 v22, 16, v204
v_and_b32 v23, v38, v204
v_lshlrev_b32 v224, 16, v212
v_and_b32 v225, v38, v212
v_add_f32 v224, v224, v22
v_add_f32 v225, v225, v23
v_lshlrev_b32 v22, 16, v205
v_and_b32 v23, v38, v205
v_lshlrev_b32 v226, 16, v213
v_and_b32 v227, v38, v213
v_add_f32 v226, v226, v22
v_add_f32 v227, v227, v23
v_lshlrev_b32 v22, 16, v206
v_and_b32 v23, v38, v206
v_lshlrev_b32 v228, 16, v214
v_and_b32 v229, v38, v214
v_add_f32 v228, v228, v22
v_add_f32 v229, v229, v23
v_lshlrev_b32 v22, 16, v207
v_and_b32 v23, v38, v207
v_lshlrev_b32 v230, 16, v215
v_and_b32 v231, v38, v215
v_add_f32 v230, v230, v22
v_add_f32 v231, v231, v23
buffer_load_dwordx4 v[136:139], v16, s[36:39], s70 offen offset:2048 sc1
s_waitcnt vmcnt(14)
v_mfma_f32_32x32x16_bf16 v[64:79], a[136:139], v[140:143], v[64:79]
v_mfma_f32_32x32x16_bf16 v[96:111], a[140:143], v[140:143], v[96:111]
buffer_load_dwordx4 v[140:143], v16, s[36:39], s70 offen offset:3072 sc1
s_waitcnt vmcnt(14)
v_mfma_f32_32x32x16_bf16 v[64:79], a[144:147], v[144:147], v[64:79]
v_mfma_f32_32x32x16_bf16 v[96:111], a[148:151], v[144:147], v[96:111]
buffer_load_dwordx4 v[144:147], v17, s[36:39], s70 offen offset:0 sc1
s_waitcnt vmcnt(14)
v_mfma_f32_32x32x16_bf16 v[64:79], a[152:155], v[148:151], v[64:79]
v_mfma_f32_32x32x16_bf16 v[96:111], a[156:159], v[148:151], v[96:111]
buffer_load_dwordx4 v[148:151], v17, s[36:39], s70 offen offset:1024 sc1
s_waitcnt vmcnt(14)
v_mfma_f32_32x32x16_bf16 v[64:79], a[160:163], v[152:155], v[64:79]
v_mfma_f32_32x32x16_bf16 v[96:111], a[164:167], v[152:155], v[96:111]
buffer_load_dwordx4 v[152:155], v17, s[36:39], s70 offen offset:2048 sc1
s_waitcnt vmcnt(13)
v_mfma_f32_32x32x16_bf16 v[64:79], a[168:171], v[156:159], v[64:79]
v_mfma_f32_32x32x16_bf16 v[96:111], a[172:175], v[156:159], v[96:111]
buffer_load_dwordx4 v[156:159], v17, s[36:39], s70 offen offset:3072 sc1
s_waitcnt vmcnt(13)
v_mfma_f32_32x32x16_bf16 v[64:79], a[176:179], v[160:163], v[64:79]
v_mfma_f32_32x32x16_bf16 v[96:111], a[180:183], v[160:163], v[96:111]
buffer_load_dwordx4 v[160:163], v18, s[36:39], s70 offen offset:0 sc1
s_waitcnt vmcnt(13)
v_mfma_f32_32x32x16_bf16 v[64:79], a[184:187], v[164:167], v[64:79]
v_mfma_f32_32x32x16_bf16 v[96:111], a[188:191], v[164:167], v[96:111]
buffer_load_dwordx4 v[164:167], v18, s[36:39], s70 offen offset:1024 sc1
s_waitcnt vmcnt(13)
v_mfma_f32_32x32x16_bf16 v[64:79], a[192:195], v[168:171], v[64:79]
v_mfma_f32_32x32x16_bf16 v[96:111], a[196:199], v[168:171], v[96:111]
buffer_load_dwordx4 v[168:171], v18, s[36:39], s70 offen offset:2048 sc1
s_waitcnt vmcnt(13)
v_mfma_f32_32x32x16_bf16 v[64:79], a[200:203], v[172:175], v[64:79]
v_mfma_f32_32x32x16_bf16 v[96:111], a[204:207], v[172:175], v[96:111]
buffer_load_dwordx4 v[172:175], v18, s[36:39], s70 offen offset:3072 sc1
s_waitcnt vmcnt(13)
v_mfma_f32_32x32x16_bf16 v[64:79], a[208:211], v[176:179], v[64:79]
v_mfma_f32_32x32x16_bf16 v[96:111], a[212:215], v[176:179], v[96:111]
buffer_load_dwordx4 v[176:179], v19, s[36:39], s70 offen offset:0 sc1
s_waitcnt vmcnt(13)
v_mfma_f32_32x32x16_bf16 v[64:79], a[216:219], v[180:183], v[64:79]
v_mfma_f32_32x32x16_bf16 v[96:111], a[220:223], v[180:183], v[96:111]
buffer_load_dwordx4 v[180:183], v19, s[36:39], s70 offen offset:1024 sc1
s_waitcnt vmcnt(13)
v_mfma_f32_32x32x16_bf16 v[80:95], a[0:3], v[128:131], 0
v_mfma_f32_32x32x16_bf16 v[112:127], a[4:7], v[128:131], 0
buffer_load_dwordx4 v[128:131], v19, s[36:39], s70 offen offset:2048 sc1
s_waitcnt vmcnt(13)
v_mfma_f32_32x32x16_bf16 v[80:95], a[8:11], v[132:135], v[80:95]
v_mfma_f32_32x32x16_bf16 v[112:127], a[12:15], v[132:135], v[112:127]
buffer_load_dwordx4 v[132:135], v19, s[36:39], s70 offen offset:3072 sc1
s_waitcnt vmcnt(13)
v_mfma_f32_32x32x16_bf16 v[80:95], a[16:19], v[136:139], v[80:95]
v_mfma_f32_32x32x16_bf16 v[112:127], a[20:23], v[136:139], v[112:127]
s_add_u32 s70, s70, 16384
buffer_load_dwordx4 v[136:139], v16, s[36:39], s70 offen offset:0 sc1
s_waitcnt vmcnt(13)
v_mfma_f32_32x32x16_bf16 v[80:95], a[24:27], v[140:143], v[80:95]
v_mfma_f32_32x32x16_bf16 v[112:127], a[28:31], v[140:143], v[112:127]
buffer_load_dwordx4 v[140:143], v16, s[36:39], s70 offen offset:1024 sc1
s_waitcnt vmcnt(13)
v_mfma_f32_32x32x16_bf16 v[80:95], a[32:35], v[144:147], v[80:95]
v_mfma_f32_32x32x16_bf16 v[112:127], a[36:39], v[144:147], v[112:127]
s_cmp_lg_u32 s20, 0
s_cbranch_scc1 nr_23
v_add_f32 v64, v64, v216
v_add_f32 v65, v65, v217
v_add_f32 v66, v66, v218
v_add_f32 v67, v67, v219
nr_23:
ds_write_b128 v5, v[64:67] offset:0
buffer_load_dwordx4 v[144:147], v16, s[36:39], s70 offen offset:2048 sc1
s_waitcnt vmcnt(13)
v_mfma_f32_32x32x16_bf16 v[80:95], a[40:43], v[148:151], v[80:95]
v_mfma_f32_32x32x16_bf16 v[112:127], a[44:47], v[148:151], v[112:127]
s_cmp_lg_u32 s20, 0
s_cbranch_scc1 nr_24
v_add_f32 v68, v68, v220
v_add_f32 v69, v69, v221
v_add_f32 v70, v70, v222
v_add_f32 v71, v71, v223
nr_24:
ds_write_b128 v5, v[68:71] offset:1088
buffer_load_dwordx4 v[148:151], v16, s[36:39], s70 offen offset:3072 sc1
s_waitcnt vmcnt(13)
v_mfma_f32_32x32x16_bf16 v[80:95], a[48:51], v[152:155], v[80:95]
v_mfma_f32_32x32x16_bf16 v[112:127], a[52:55], v[152:155], v[112:127]
s_cmp_lg_u32 s20, 0
s_cbranch_scc1 nr_25
v_add_f32 v72, v72, v224
v_add_f32 v73, v73, v225
v_add_f32 v74, v74, v226
v_add_f32 v75, v75, v227
nr_25:
ds_write_b128 v5, v[72:75] offset:2176
buffer_load_dwordx4 v[152:155], v17, s[36:39], s70 offen offset:0 sc1
s_waitcnt vmcnt(13)
v_mfma_f32_32x32x16_bf16 v[80:95], a[56:59], v[156:159], v[80:95]
v_mfma_f32_32x32x16_bf16 v[112:127], a[60:63], v[156:159], v[112:127]
s_cmp_lg_u32 s20, 0
s_cbranch_scc1 nr_26
v_add_f32 v76, v76, v228
v_add_f32 v77, v77, v229
v_add_f32 v78, v78, v230
v_add_f32 v79, v79, v231
nr_26:
ds_write_b128 v5, v[76:79] offset:3264
buffer_load_dwordx4 v[156:159], v17, s[36:39], s70 offen offset:1024 sc1
s_waitcnt vmcnt(13)
v_mfma_f32_32x32x16_bf16 v[80:95], a[64:67], v[160:163], v[80:95]
v_mfma_f32_32x32x16_bf16 v[112:127], a[68:71], v[160:163], v[112:127]
s_cmp_lg_u32 s20, 2
s_cbranch_scc1 nr_27
v_add_f32 v96, v96, v216
v_add_f32 v97, v97, v217
v_add_f32 v98, v98, v218
v_add_f32 v99, v99, v219
nr_27:
ds_write_b128 v5, v[96:99] offset:34816
buffer_load_dwordx4 v[160:163], v17, s[36:39], s70 offen offset:2048 sc1
s_waitcnt vmcnt(13)
v_mfma_f32_32x32x16_bf16 v[80:95], a[72:75], v[164:167], v[80:95]
v_mfma_f32_32x32x16_bf16 v[112:127], a[76:79], v[164:167], v[112:127]
s_cmp_lg_u32 s20, 2
s_cbranch_scc1 nr_28
v_add_f32 v100, v100, v220
v_add_f32 v101, v101, v221
v_add_f32 v102, v102, v222
v_add_f32 v103, v103, v223
nr_28:
ds_write_b128 v5, v[100:103] offset:35904
buffer_load_dwordx4 v[164:167], v17, s[36:39], s70 offen offset:3072 sc1
s_waitcnt vmcnt(13)
v_mfma_f32_32x32x16_bf16 v[80:95], a[80:83], v[168:171], v[80:95]
v_mfma_f32_32x32x16_bf16 v[112:127], a[84:87], v[168:171], v[112:127]
s_cmp_lg_u32 s20, 2
s_cbranch_scc1 nr_29
v_add_f32 v104, v104, v224
v_add_f32 v105, v105, v225
v_add_f32 v106, v106, v226
v_add_f32 v107, v107, v227
nr_29:
ds_write_b128 v5, v[104:107] offset:36992
buffer_load_dwordx4 v[168:171], v18, s[36:39], s70 offen offset:0 sc1
s_waitcnt vmcnt(13)
v_mfma_f32_32x32x16_bf16 v[80:95], a[88:91], v[172:175], v[80:95]
v_mfma_f32_32x32x16_bf16 v[112:127], a[92:95], v[172:175], v[112:127]
s_cmp_lg_u32 s20, 2
s_cbranch_scc1 nr_30
v_add_f32 v108, v108, v228
v_add_f32 v109, v109, v229
v_add_f32 v110, v110, v230
v_add_f32 v111, v111, v231
nr_30:
ds_write_b128 v5, v[108:111] offset:38080
buffer_load_dwordx4 v[172:175], v18, s[36:39], s70 offen offset:1024 sc1
s_waitcnt vmcnt(13)
v_mfma_f32_32x32x16_bf16 v[80:95], a[96:99], v[176:179], v[80:95]
v_mfma_f32_32x32x16_bf16 v[112:127], a[100:103], v[176:179], v[112:127]
buffer_load_dwordx4 v[176:179], v18, s[36:39], s70 offen offset:2048 sc1
s_waitcnt vmcnt(13)
v_mfma_f32_32x32x16_bf16 v[80:95], a[104:107], v[180:183], v[80:95]
v_mfma_f32_32x32x16_bf16 v[112:127], a[108:111], v[180:183], v[112:127]
buffer_load_dwordx4 v[180:183], v18, s[36:39], s70 offen offset:3072 sc1
s_waitcnt vmcnt(13)
v_mfma_f32_32x32x16_bf16 v[80:95], a[112:115], v[128:131], v[80:95]
v_mfma_f32_32x32x16_bf16 v[112:127], a[116:119], v[128:131], v[112:127]
s_waitcnt vmcnt(12)
v_mfma_f32_32x32x16_bf16 v[80:95], a[120:123], v[132:135], v[80:95]
v_mfma_f32_32x32x16_bf16 v[112:127], a[124:127], v[132:135], v[112:127]
s_waitcnt vmcnt(11)
v_mfma_f32_32x32x16_bf16 v[80:95], a[128:131], v[136:139], v[80:95]
v_mfma_f32_32x32x16_bf16 v[112:127], a[132:135], v[136:139], v[112:127]
s_waitcnt vmcnt(10)
v_mfma_f32_32x32x16_bf16 v[80:95], a[136:139], v[140:143], v[80:95]
v_mfma_f32_32x32x16_bf16 v[112:127], a[140:143], v[140:143], v[112:127]
s_waitcnt vmcnt(9)
v_mfma_f32_32x32x16_bf16 v[80:95], a[144:147], v[144:147], v[80:95]
v_mfma_f32_32x32x16_bf16 v[112:127], a[148:151], v[144:147], v[112:127]
s_waitcnt vmcnt(8)
v_mfma_f32_32x32x16_bf16 v[80:95], a[152:155], v[148:151], v[80:95]
v_mfma_f32_32x32x16_bf16 v[112:127], a[156:159], v[148:151], v[112:127]
s_waitcnt vmcnt(7)
v_mfma_f32_32x32x16_bf16 v[80:95], a[160:163], v[152:155], v[80:95]
v_mfma_f32_32x32x16_bf16 v[112:127], a[164:167], v[152:155], v[112:127]
s_waitcnt vmcnt(6)
v_mfma_f32_32x32x16_bf16 v[80:95], a[168:171], v[156:159], v[80:95]
v_mfma_f32_32x32x16_bf16 v[112:127], a[172:175], v[156:159], v[112:127]
s_waitcnt vmcnt(5)
v_mfma_f32_32x32x16_bf16 v[80:95], a[176:179], v[160:163], v[80:95]
v_mfma_f32_32x32x16_bf16 v[112:127], a[180:183], v[160:163], v[112:127]
s_waitcnt vmcnt(4)
v_mfma_f32_32x32x16_bf16 v[80:95], a[184:187], v[164:167], v[80:95]
v_mfma_f32_32x32x16_bf16 v[112:127], a[188:191], v[164:167], v[112:127]
s_waitcnt vmcnt(3)
v_mfma_f32_32x32x16_bf16 v[80:95], a[192:195], v[168:171], v[80:95]
v_mfma_f32_32x32x16_bf16 v[112:127], a[196:199], v[168:171], v[112:127]
s_waitcnt vmcnt(2)
v_mfma_f32_32x32x16_bf16 v[80:95], a[200:203], v[172:175], v[80:95]
v_mfma_f32_32x32x16_bf16 v[112:127], a[204:207], v[172:175], v[112:127]
s_waitcnt vmcnt(1)
v_mfma_f32_32x32x16_bf16 v[80:95], a[208:211], v[176:179], v[80:95]
v_mfma_f32_32x32x16_bf16 v[112:127], a[212:215], v[176:179], v[112:127]
s_waitcnt vmcnt(0)
v_mfma_f32_32x32x16_bf16 v[80:95], a[216:219], v[180:183], v[80:95]
v_mfma_f32_32x32x16_bf16 v[112:127], a[220:223], v[180:183], v[112:127]
s_nop 7
s_nop 3
s_cmp_lg_u32 s20, 1
s_cbranch_scc1 nr_31
v_add_f32 v80, v80, v216
v_add_f32 v81, v81, v217
v_add_f32 v82, v82, v218
v_add_f32 v83, v83, v219
v_add_f32 v84, v84, v220
v_add_f32 v85, v85, v221
v_add_f32 v86, v86, v222
v_add_f32 v87, v87, v223
v_add_f32 v88, v88, v224
v_add_f32 v89, v89, v225
v_add_f32 v90, v90, v226
v_add_f32 v91, v91, v227
v_add_f32 v92, v92, v228
v_add_f32 v93, v93, v229
v_add_f32 v94, v94, v230
v_add_f32 v95, v95, v231
nr_31:
ds_write_b128 v5, v[80:83] offset:17408
ds_write_b128 v5, v[84:87] offset:18496
ds_write_b128 v5, v[88:91] offset:19584
ds_write_b128 v5, v[92:95] offset:20672
s_cmp_lg_u32 s20, 3
s_cbranch_scc1 nr_32
v_add_f32 v112, v112, v216
v_add_f32 v113, v113, v217
v_add_f32 v114, v114, v218
v_add_f32 v115, v115, v219
v_add_f32 v116, v116, v220
v_add_f32 v117, v117, v221
v_add_f32 v118, v118, v222
v_add_f32 v119, v119, v223
v_add_f32 v120, v120, v224
v_add_f32 v121, v121, v225
v_add_f32 v122, v122, v226
v_add_f32 v123, v123, v227
v_add_f32 v124, v124, v228
v_add_f32 v125, v125, v229
v_add_f32 v126, v126, v230
v_add_f32 v127, v127, v231
nr_32:
ds_write_b128 v5, v[112:115] offset:52224
ds_write_b128 v5, v[116:119] offset:53312
ds_write_b128 v5, v[120:123] offset:54400
ds_write_b128 v5, v[124:127] offset:55488
v_add_u32 v22, 7168, v21
s_waitcnt lgkmcnt(0)
s_barrier
ds_read_b128 v[128:131], v6 offset:0
ds_read_b128 v[132:135], v6 offset:512
ds_read_b128 v[136:139], v6 offset:4352
ds_read_b128 v[140:143], v6 offset:4864
ds_read_b128 v[144:147], v6 offset:8704
ds_read_b128 v[148:151], v6 offset:9216
ds_read_b128 v[152:155], v6 offset:13056
ds_read_b128 v[156:159], v6 offset:13568
ds_read_b128 v[160:163], v6 offset:128
ds_read_b128 v[164:167], v6 offset:640
ds_read_b128 v[168:171], v6 offset:4480
ds_read_b128 v[172:175], v6 offset:4992
ds_read_b128 v[176:179], v6 offset:8832
ds_read_b128 v[180:183], v6 offset:9344
ds_read_b128 v[184:187], v6 offset:13184
ds_read_b128 v[188:191], v6 offset:13696
s_waitcnt lgkmcnt(8)
v_pk_add_f32 v[128:129], v[128:129], v[136:137]
v_pk_add_f32 v[144:145], v[144:145], v[152:153]
v_pk_add_f32 v[128:129], v[128:129], v[144:145]
v_pk_add_f32 v[130:131], v[130:131], v[138:139]
v_pk_add_f32 v[146:147], v[146:147], v[154:155]
v_pk_add_f32 v[130:131], v[130:131], v[146:147]
v_pk_add_f32 v[132:133], v[132:133], v[140:141]
v_pk_add_f32 v[148:149], v[148:149], v[156:157]
v_pk_add_f32 v[132:133], v[132:133], v[148:149]
v_pk_add_f32 v[134:135], v[134:135], v[142:143]
v_pk_add_f32 v[150:151], v[150:151], v[158:159]
v_pk_add_f32 v[134:135], v[134:135], v[150:151]
v_cvt_pk_bf16_f32 v40, v128, v129
v_cvt_pk_bf16_f32 v41, v130, v131
v_cvt_pk_bf16_f32 v42, v132, v133
v_cvt_pk_bf16_f32 v43, v134, v135
buffer_store_dwordx4 v[40:43], v21, s[40:43], 0 offen sc1
s_waitcnt lgkmcnt(0)
v_pk_add_f32 v[160:161], v[160:161], v[168:169]
v_pk_add_f32 v[176:177], v[176:177], v[184:185]
v_pk_add_f32 v[160:161], v[160:161], v[176:177]
v_pk_add_f32 v[162:163], v[162:163], v[170:171]
v_pk_add_f32 v[178:179], v[178:179], v[186:187]
v_pk_add_f32 v[162:163], v[162:163], v[178:179]
v_pk_add_f32 v[164:165], v[164:165], v[172:173]
v_pk_add_f32 v[180:181], v[180:181], v[188:189]
v_pk_add_f32 v[164:165], v[164:165], v[180:181]
v_pk_add_f32 v[166:167], v[166:167], v[174:175]
v_pk_add_f32 v[182:183], v[182:183], v[190:191]
v_pk_add_f32 v[166:167], v[166:167], v[182:183]
v_cvt_pk_bf16_f32 v44, v160, v161
v_cvt_pk_bf16_f32 v45, v162, v163
v_cvt_pk_bf16_f32 v46, v164, v165
v_cvt_pk_bf16_f32 v47, v166, v167
buffer_store_dwordx4 v[44:47], v22, s[40:43], 0 offen sc1
s_endpgm
ffn_kernel_pf:
s_sub_u32 s17, s17, 28
v_lshlrev_b32 v4, 7, v0
v_lshrrev_b32 v2, 4, v0
v_and_b32 v3, 15, v0
v_mul_u32_u24 v5, 37, v2
v_lshrrev_b32 v5, 8, v5
v_mul_u32_u24 v6, 7, v5
v_sub_u32 v6, v2, v6
s_mul_i32 s22, s17, 7
v_add_u32 v6, s22, v6
s_mov_b32 s23, 57344
v_mul_lo_u32 v6, v6, s23
v_lshlrev_b32 v5, 11, v5
v_add_u32 v6, v6, v5
v_lshl_add_u32 v6, v3, 7, v6
s_waitcnt lgkmcnt(0)

s_add_u32 s24, s12, 4325376
s_addc_u32 s25, s13, 0
s_mov_b32 s26, 229376
s_mov_b32 s27, 0x20000
s_lshl_b32 s18, s16, 10
s_add_u32 s18, s18, 114688
s_mov_b64 exec, 0xff
buffer_load_dword v8, v4, s[24:27], s18 offen
s_mov_b64 exec, -1
s_mov_b32 s24, s4
s_mov_b32 s25, s5
s_mov_b32 s26, 1605632
s_mov_b32 s27, 0x20000
s_lshl_b32 s22, s17, 15
s_add_u32 s22, s22, 229376
buffer_load_dword v8, v4, s[24:27], s22 offen
s_add_u32 s22, s22, 131072
buffer_load_dword v8, v4, s[24:27], s22 offen
s_add_u32 s22, s22, 131072
buffer_load_dword v8, v4, s[24:27], s22 offen
s_add_u32 s22, s22, 131072
buffer_load_dword v8, v4, s[24:27], s22 offen
s_add_u32 s22, s22, 131072
s_waitcnt vmcnt(3)
buffer_load_dword v8, v4, s[24:27], s22 offen
s_add_u32 s22, s22, 131072
s_waitcnt vmcnt(3)
buffer_load_dword v8, v4, s[24:27], s22 offen
s_add_u32 s22, s22, 131072
s_waitcnt vmcnt(3)
buffer_load_dword v8, v4, s[24:27], s22 offen
s_add_u32 s22, s22, 131072
s_waitcnt vmcnt(3)
buffer_load_dword v8, v4, s[24:27], s22 offen
s_add_u32 s22, s22, 131072
s_waitcnt vmcnt(3)
buffer_load_dword v8, v4, s[24:27], s22 offen
s_add_u32 s22, s22, 131072
s_waitcnt vmcnt(3)
buffer_load_dword v8, v4, s[24:27], s22 offen
s_add_u32 s22, s22, 131072
s_waitcnt vmcnt(3)
buffer_load_dword v8, v4, s[24:27], s22 offen
s_add_u32 s22, s22, 131072
s_waitcnt vmcnt(3)
s_add_u32 s24, s12, 8388608
s_addc_u32 s25, s13, 0
s_mov_b32 s26, 7340032
s_mov_b32 s27, 0x20000
s_cmp_eq_u32 s16, 7
s_cbranch_scc1 x7_33
s_lshr_b32 s18, s17, 1
s_add_u32 s18, s18, 2
s_lshl_b32 s19, s16, 2
s_add_u32 s18, s18, s19
s_mul_i32 s18, s18, 229376
s_and_b32 s19, s17, 1
s_mul_i32 s19, s19, 114688
s_add_u32 s18, s18, s19
buffer_load_dword v8, v4, s[24:27], s18 offen
s_add_u32 s18, s18, 32768
s_waitcnt vmcnt(3)
buffer_load_dword v8, v4, s[24:27], s18 offen
s_add_u32 s18, s18, 32768
s_waitcnt vmcnt(3)
buffer_load_dword v8, v4, s[24:27], s18 offen
s_add_u32 s18, s18, 32768
s_waitcnt vmcnt(3)
buffer_load_dword v8, v4, s[24:27], s18 offen
s_add_u32 s18, s18, 32768
s_waitcnt vmcnt(3)
s_branch go_34
x7_33:
s_lshl_b32 s18, s16, 2
s_add_u32 s18, s18, s17
s_mul_i32 s18, s18, 229376
buffer_load_dword v8, v4, s[24:27], s18 offen
s_add_u32 s18, s18, 32768
s_waitcnt vmcnt(3)
buffer_load_dword v8, v4, s[24:27], s18 offen
s_add_u32 s18, s18, 32768
s_waitcnt vmcnt(3)
buffer_load_dword v8, v4, s[24:27], s18 offen
s_add_u32 s18, s18, 32768
s_waitcnt vmcnt(3)
buffer_load_dword v8, v4, s[24:27], s18 offen
s_add_u32 s18, s18, 32768
s_waitcnt vmcnt(3)
buffer_load_dword v8, v4, s[24:27], s18 offen
s_add_u32 s18, s18, 32768
s_waitcnt vmcnt(3)
buffer_load_dword v8, v4, s[24:27], s18 offen
s_add_u32 s18, s18, 32768
s_waitcnt vmcnt(3)
buffer_load_dword v8, v4, s[24:27], s18 offen
s_add_u32 s18, s18, 32768
s_waitcnt vmcnt(3)
go_34:
s_add_u32 s24, s12, 18382848
s_addc_u32 s25, s13, 0
s_mov_b32 s26, 1605632
s_mov_b32 s27, 0x20000
v_cmp_gt_u32 vcc, 14, v2
s_and_saveexec_b64 s[60:61], vcc
s_cbranch_execz w2x_35
s_mov_b32 s22, 0
buffer_load_dword v8, v6, s[24:27], s22 offen
s_add_u32 s22, s22, 4096
s_waitcnt vmcnt(3)
buffer_load_dword v8, v6, s[24:27], s22 offen
s_add_u32 s22, s22, 4096
s_waitcnt vmcnt(3)
buffer_load_dword v8, v6, s[24:27], s22 offen
s_add_u32 s22, s22, 4096
s_waitcnt vmcnt(3)
buffer_load_dword v8, v6, s[24:27], s22 offen
s_add_u32 s22, s22, 4096
s_waitcnt vmcnt(3)
buffer_load_dword v8, v6, s[24:27], s22 offen
s_add_u32 s22, s22, 4096
s_waitcnt vmcnt(3)
buffer_load_dword v8, v6, s[24:27], s22 offen
s_add_u32 s22, s22, 4096
s_waitcnt vmcnt(3)
buffer_load_dword v8, v6, s[24:27], s22 offen
s_add_u32 s22, s22, 4096
s_waitcnt vmcnt(3)
buffer_load_dword v8, v6, s[24:27], s22 offen
s_add_u32 s22, s22, 4096
s_waitcnt vmcnt(3)
buffer_load_dword v8, v6, s[24:27], s22 offen
s_add_u32 s22, s22, 4096
s_waitcnt vmcnt(3)
buffer_load_dword v8, v6, s[24:27], s22 offen
s_add_u32 s22, s22, 4096
s_waitcnt vmcnt(3)
buffer_load_dword v8, v6, s[24:27], s22 offen
s_add_u32 s22, s22, 4096
s_waitcnt vmcnt(3)
buffer_load_dword v8, v6, s[24:27], s22 offen
s_add_u32 s22, s22, 4096
s_waitcnt vmcnt(3)
buffer_load_dword v8, v6, s[24:27], s22 offen
s_add_u32 s22, s22, 4096
s_waitcnt vmcnt(3)
buffer_load_dword v8, v6, s[24:27], s22 offen
s_add_u32 s22, s22, 4096
s_waitcnt vmcnt(3)
w2x_35:
s_mov_b64 exec, -1
ffn_kernel_done:
s_endpgm
.section .rodata,"a"
.p2align 6
.amdhsa_kernel conv_kernel
  .amdhsa_next_free_vgpr 240
  .amdhsa_next_free_sgpr 102
  .amdhsa_accum_offset 240
  .amdhsa_group_segment_fixed_size 0
  .amdhsa_kernarg_size 112
  .amdhsa_user_sgpr_count 2
  .amdhsa_user_sgpr_kernarg_segment_ptr 1
  .amdhsa_system_sgpr_workgroup_id_x 1
  .amdhsa_float_denorm_mode_32 3
  .amdhsa_ieee_mode 0
  .amdhsa_dx10_clamp 0
.end_amdhsa_kernel
.section .rodata,"a"
.p2align 6
.amdhsa_kernel ffn_kernel
  .amdhsa_next_free_vgpr 512
  .amdhsa_next_free_sgpr 102
  .amdhsa_accum_offset 256
  .amdhsa_group_segment_fixed_size 0
  .amdhsa_kernarg_size 112
  .amdhsa_user_sgpr_count 2
  .amdhsa_user_sgpr_kernarg_segment_ptr 1
  .amdhsa_system_sgpr_workgroup_id_x 1
  .amdhsa_float_denorm_mode_32 3
  .amdhsa_ieee_mode 0
  .amdhsa_dx10_clamp 0
.end_amdhsa_kernel
```
